```python
import torch

def _softmax(x, axis=-1):
    return torch.softmax(x, dim=axis)
def _gelu(x):
    return torch.nn.functional.gelu(x, approximate="tanh")
def _silu(x):
    return torch.nn.functional.silu(x)
def _sigmoid(x):
    return torch.sigmoid(x)
def _layernorm(x, axis=-1, eps=1e-5):
    m = x.mean(dim=axis, keepdim=True)
    v = x.var(dim=axis, keepdim=True, unbiased=False)
    return (x - m) / torch.sqrt(v + eps)
def _scatter_add(tgt, idx, src, axis=0):
    return tgt.clone().index_add_(axis, idx, src)
def _segment_sum(src, seg, n):
    out = torch.zeros((n,) + src.shape[1:], dtype=src.dtype)
    return out.index_add_(0, seg, src)
def _pad(x, pw):
    flat = tuple(v for pair in reversed(pw) for v in pair)
    return torch.nn.functional.pad(x, flat)

kernel_name = 'sequential_preLN__spectral_gfnet__mixer_token_mlp__prompt'

def setup_inputs():

    _w = (lambda a: (lambda t: t.to(torch.bfloat16) if t.is_floating_point() else t)(torch.as_tensor(a)))
    def _A_setup():
        B, S, D = 1, 2048, 512
        Df = D // 2 + 1
        return {
            "x": _w((lambda *s: torch.randn(*s, dtype=torch.bfloat16) * 0.05)(B, S, D)),
            "w_r": _w((lambda *s: torch.randn(*s, dtype=torch.bfloat16) * 0.2)(S, Df) * 0.02),
            "w_i": _w((lambda *s: torch.randn(*s, dtype=torch.bfloat16) * 0.2)(S, Df) * 0.02),
        }
    _A_in = _A_setup()

    def _B_setup():
        B, S, D, F = 1, 2048, 512, 1376
        return {
            "x": _w((lambda *s: torch.randn(*s, dtype=torch.bfloat16) * 0.05)(B, S, D)),
            "w1": _w((lambda *s: torch.randn(*s, dtype=torch.bfloat16) * 0.4)(S, F) * (S ** -0.5)),
            "b1": _w((lambda *s: torch.randn(*s, dtype=torch.bfloat16) * 3.2)(F) * 0.02),
            "w2": _w((lambda *s: torch.randn(*s, dtype=torch.bfloat16) * 0.2)(F, S) * (F ** -0.5)),
            "b2": _w((lambda *s: torch.randn(*s, dtype=torch.bfloat16) * 0.4)(S) * 0.02),
        }
    _B_in = _B_setup()

    return {
        "A_x": _A_in["x"],
        "A_w_r": _A_in["w_r"],
        "A_w_i": _A_in["w_i"],
        "B_x": _B_in["x"],
        "B_w1": _B_in["w1"],
        "B_b1": _B_in["b1"],
        "B_w2": _B_in["w2"],
        "B_b2": _B_in["b2"],
    }

def reference(A_x, A_w_r, A_w_i, B_x, B_w1, B_b1, B_w2, B_b2):
    def _A_ref(x, w_r, w_i):
        B, S, D = x.shape
        X = (lambda x, axes=(-2,-1): torch.fft.rfft2(x.float(), dim=axes))(x, axes=(-2, -1))
        W = w_r + 1j * w_i
        X = X * W
        y = (lambda x, s, axes=(-2,-1): torch.fft.irfft2(x, s=s, dim=axes).to(torch.bfloat16))(X, (S, D), axes=(-2, -1))
        return y

    def _B_ref(x, w1, b1, w2, b2):
        B, S, D = x.shape
        h = _layernorm(x, axis=-1)
        u = torch.einsum("bsd,sf->bdf", h, w1) + b1
        u = _gelu(u)
        y = torch.einsum("bdf,fs->bds", u, w2) + b2
        return (lambda x, *d: x.permute(*d))(y, 0, 2, 1)

    x = A_x
    h = x + _A_ref(_layernorm(x, axis=-1), A_w_r, A_w_i)
    h2 = h + _B_ref(_layernorm(h, axis=-1), B_w1, B_b1, B_w2, B_b2)
    return h2
```

```asm
; @launch grid=(256,1,1) block=(256,1,1) lds=163840
.amdgcn_target "amdgcn-amd-amdhsa--gfx950"
.text
.globl sequential_preLN__spectral_gfnet__mixer_token_mlp__prompt_kernel
.p2align 8
.type sequential_preLN__spectral_gfnet__mixer_token_mlp__prompt_kernel,@function
sequential_preLN__spectral_gfnet__mixer_token_mlp__prompt_kernel:
	s_cmp_ge_u32 s2, 256
	s_cbranch_scc1 L_end
	s_getpc_b64 s[26:27]
L_pc:
	s_load_dwordx4 s[4:7], s[0:1], 0
	s_load_dwordx2 s[24:25], s[0:1], 80
	s_load_dwordx2 s[8:9], s[0:1], 16
	s_load_dwordx4 s[12:15], s[0:1], 32
	s_load_dwordx4 s[16:19], s[0:1], 48
	s_load_dwordx4 s[20:23], s[0:1], 64
	s_bfe_u32 s28, s2, 0x30003
	s_mul_i32 s28, s28, ((L_tables-L_pc)/1024+1)*128
	v_min_u32 v4, ((L_tables-L_pc)/1024), v0
	v_lshlrev_b32 v4, 7, v4
	v_add_u32 v4, s28, v4
	v_min_u32 v4, L_tables-L_pc, v4
	global_load_dword v23, v4, s[26:27]
	s_add_u32 s26, s26, L_tables-L_pc
	s_addc_u32 s27, s27, 0
	v_lshrrev_b32 v4, 6, v0
	v_and_b32 v1, 63, v0
	v_and_b32 v2, 15, v0
	v_readfirstlane_b32 s3, v4
	v_lshrrev_b32 v3, 4, v1
	v_lshlrev_b32 v21, 4, v1
	v_mov_b32 v22, 0x3f803f80
	s_and_b32 s30, s2, 31
	s_lshr_b32 s31, s2, 5
	s_lshr_b32 s32, s31, 1
	s_and_b32 s33, s31, 1
	s_lshl_b32 s32, s32, 3
	s_lshl_b32 s34, s3, 1
	s_add_u32 s32, s32, s34
	s_add_u32 s32, s32, s33
	s_lshl_b32 s32, s32, 5
	s_add_u32 s30, s30, s32
	s_lshl_b32 s31, s30, 11
	v_lshlrev_b32 v144, 8, v3
	v_lshl_add_u32 v144, v2, 2, v144
	v_lshlrev_b32 v145, 3, v1
	s_mul_i32 s32, s30, 514
	s_waitcnt lgkmcnt(0)
	s_add_u32 s34, s4, s31
	s_addc_u32 s35, s5, 0
	global_load_dword v24, v144, s[34:35] offset:0
	global_load_dword v25, v144, s[34:35] offset:64
	global_load_dword v26, v144, s[34:35] offset:128
	global_load_dword v27, v144, s[34:35] offset:192
	global_load_dword v28, v144, s[34:35] offset:1024
	global_load_dword v29, v144, s[34:35] offset:1088
	global_load_dword v30, v144, s[34:35] offset:1152
	global_load_dword v31, v144, s[34:35] offset:1216
	v_mov_b32 v196, -1
	v_mov_b32 v197, -1
	v_mov_b32 v198, -1
	v_mov_b32 v199, -1
	v_lshlrev_b32 v200, 4, v0
	s_mul_i32 s45, s2, 16512
	s_lshl_b32 s50, s3, 12
	s_add_u32 s45, s45, s50
	s_add_u32 s50, s24, s45
	s_addc_u32 s51, s25, 0
	s_lshl_b32 s45, s2, 13
	s_add_u32 s52, s24, s45
	s_addc_u32 s53, s25, 0
	s_add_u32 s52, s52, 5242880
	s_addc_u32 s53, s53, 0
	global_store_dwordx4 v21, v[196:199], s[50:51] offset:0 sc1
	global_store_dwordx4 v21, v[196:199], s[50:51] offset:1024 sc1
	global_store_dwordx4 v21, v[196:199], s[50:51] offset:2048 sc1
	global_store_dwordx4 v21, v[196:199], s[50:51] offset:3072 sc1
	s_cmp_lg_u32 s3, 0
	s_cbranch_scc1 L_1
	s_add_u32 s62, s50, 16384
	s_addc_u32 s63, s51, 0
	s_mov_b64 exec, 0xf
	global_store_dwordx4 v21, v[196:199], s[62:63] sc1
	s_mov_b64 exec, -1
L_1:
	s_add_u32 s62, s52, 0
	s_addc_u32 s63, s53, 0
	global_store_dwordx4 v200, v[196:199], s[62:63] sc1
	s_add_u32 s62, s52, 4096
	s_addc_u32 s63, s53, 0
	global_store_dwordx4 v200, v[196:199], s[62:63] sc1
	s_add_u32 s28, s24, 13631488
	s_addc_u32 s29, s25, 0
	s_load_dwordx2 s[10:11], s[28:29], 0
	s_add_u32 s34, s6, s32
	s_addc_u32 s35, s7, 0
	s_add_u32 s40, s8, s32
	s_addc_u32 s41, s9, 0
	s_add_u32 s42, s34, 526336
	s_addc_u32 s43, s35, 0
	s_add_u32 s54, s40, 526336
	s_addc_u32 s55, s41, 0
	v_and_b32 v4, 1, v1
	v_bfe_u32 v5, v1, 1, 1
	v_lshlrev_b32 v6, 10, v5
	v_add_u32 v6, s30, v6
	v_sub_u32 v7, 0x800, v6
	v_and_b32 v7, 0x7ff, v7
	v_mul_u32_u24 v6, 514, v6
	v_mul_u32_u24 v7, 514, v7
	v_lshlrev_b32 v4, 9, v4
	v_add_u32 v146, v6, v4
	v_add_u32 v147, v7, v4
	s_mul_i32 s44, s3, 4384
	s_add_u32 s44, s44, 126976
	v_mul_u32_u24 v5, 1040, v5
	v_lshl_add_u32 v5, v4, 1, v5
	v_add_u32 v5, s44, v5
	v_add_u32 v155, 2304, v5
	s_and_b32 s30, s2, 7
	s_lshl_b32 s30, s30, 2
	s_lshr_b32 s31, s2, 6
	s_add_u32 s100, s30, s31
	s_bfe_u32 s97, s2, 0x30003
	s_mov_b32 s100, s100
	s_mov_b32 s97, s97
	s_mul_i32 s96, s100, 48
	s_min_u32 s96, s96, 1328
	s_mul_i32 s66, s3, 24576
	s_lshl_b32 s67, s3, 13
	s_add_u32 s67, s67, 98304
	s_mov_b32 s101, s97
	v_add_u32 v4, 0, v1
	v_mul_u32_u24 v5, 171, v4
	v_lshrrev_b32 v5, 10, v5
	v_mul_u32_u24 v6, 6, v5
	v_sub_u32 v4, v4, v6
	v_mul_u32_u24 v5, 2752, v5
	v_lshl_add_u32 v16, v4, 4, v5
	v_mov_b32 v210, v16
	v_add_u32 v4, 64, v1
	v_mul_u32_u24 v5, 171, v4
	v_lshrrev_b32 v5, 10, v5
	v_mul_u32_u24 v6, 6, v5
	v_sub_u32 v4, v4, v6
	v_mul_u32_u24 v5, 2752, v5
	v_lshl_add_u32 v17, v4, 4, v5
	v_mov_b32 v211, v17
	v_add_u32 v4, 128, v1
	v_mul_u32_u24 v5, 171, v4
	v_lshrrev_b32 v5, 10, v5
	v_mul_u32_u24 v6, 6, v5
	v_sub_u32 v4, v4, v6
	v_mul_u32_u24 v5, 2752, v5
	v_lshl_add_u32 v18, v4, 4, v5
	v_mov_b32 v212, v18
	s_mul_i32 s37, s3, 1409024
	s_lshl_b32 s38, s96, 1
	s_add_u32 s37, s37, s38
	s_add_u32 s64, s12, s37
	s_addc_u32 s65, s13, 0
	s_mov_b32 s98, 0
	s_mov_b32 s99, s66
	s_mov_b32 s101, 88064
	s_mov_b32 s0, 3072
	v_lshrrev_b32 v4, 1, v3
	v_lshlrev_b32 v4, 4, v4
	v_and_b32 v5, 1, v3
	v_lshl_add_u32 v4, v5, 1, v4
	v_lshrrev_b32 v5, 3, v2
	v_lshl_add_u32 v4, v5, 2, v4
	v_bfe_u32 v5, v2, 2, 1
	v_add_u32 v4, v4, v5
	v_mul_u32_u24 v4, 96, v4
	v_add_u32 v4, s66, v4
	v_and_b32 v5, 3, v2
	v_lshl_add_u32 v213, v5, 4, v4
	v_lshl_add_u32 v4, v5, 3, v4
	v_add_u32 v214, 64, v4
	v_lshrrev_b32 v4, 3, v1
	v_and_b32 v5, 7, v1
	v_bfe_u32 v6, v1, 4, 1
	v_lshlrev_b32 v6, 1, v6
	v_xor_b32 v5, v5, v6
	v_lshlrev_b32 v4, 12, v4
	v_lshl_add_u32 v10, v5, 4, v4
	v_xor_b32 v11, 64, v10
	v_lshrrev_b32 v4, 2, v2
	v_lshl_add_u32 v4, v3, 3, v4
	v_lshlrev_b32 v4, 7, v4
	v_and_b32 v5, 3, v2
	v_lshl_add_u32 v4, v5, 3, v4
	v_add_u32 v4, s66, v4
	v_bfe_u32 v5, v2, 3, 1
	v_and_b32 v6, 1, v3
	v_lshl_add_u32 v5, v6, 1, v5
	v_add_u32 v19, 0x18000, v11
	s_xor_b32 s37, s3, 0
	v_xor_b32 v6, s37, v5
	v_lshl_add_u32 v12, v6, 5, v4
	s_xor_b32 s37, s3, 1
	v_xor_b32 v6, s37, v5
	v_lshl_add_u32 v13, v6, 5, v4
	s_xor_b32 s37, s3, 2
	v_xor_b32 v6, s37, v5
	v_lshl_add_u32 v14, v6, 5, v4
	s_xor_b32 s37, s3, 3
	v_xor_b32 v6, s37, v5
	v_lshl_add_u32 v15, v6, 5, v4
	s_mul_i32 s37, s3, 1441792
	s_lshl_b32 s38, s100, 7
	s_add_u32 s37, s37, s38
	s_add_u32 s68, s16, s37
	s_addc_u32 s69, s17, 0
	v_mul_u32_u24 v148, 144, v3
	v_add_u32 v148, v148, v2
	v_lshlrev_b32 v148, 2, v148
	v_add_u32 v148, s44, v148
	v_add_u32 v154, s44, v21
	v_lshrrev_b32 v4, 2, v1
	s_lshl_b32 s47, s3, 6
	v_add_u32 v4, s47, v4
	v_and_b32 v5, 3, v1
	v_cmp_eq_u32 vcc, 1, v5
	v_mov_b32 v6, 0
	v_mov_b32 v7, 0x80000000
	v_cndmask_b32 v153, v6, v7, vcc
	v_add_u32 v6, 0, v4
	v_sub_u32 v7, 0x200, v6
	v_cmp_eq_u32 vcc, 0, v6
	v_mov_b32 v8, 0x100
	s_nop 0
	v_cndmask_b32 v7, v7, v8, vcc
	v_cmp_eq_u32 vcc, 1, v5
	s_nop 1
	v_cndmask_b32 v7, v6, v7, vcc
	v_lshrrev_b32 v8, 7, v7
	v_lshl_add_u32 v7, v8, 4, v7
	v_add_u32 v8, 576, v6
	v_cmp_eq_u32 vcc, 2, v5
	s_nop 1
	v_cndmask_b32 v7, v7, v8, vcc
	v_add_u32 v8, 836, v6
	v_cmp_eq_u32 vcc, 3, v5
	s_nop 1
	v_cndmask_b32 v7, v7, v8, vcc
	v_lshlrev_b32 v7, 2, v7
	v_add_u32 v149, 126976, v7
	v_add_u32 v6, 16, v4
	v_sub_u32 v7, 0x200, v6
	v_cmp_eq_u32 vcc, 0, v6
	v_mov_b32 v8, 0x100
	s_nop 0
	v_cndmask_b32 v7, v7, v8, vcc
	v_cmp_eq_u32 vcc, 1, v5
	s_nop 1
	v_cndmask_b32 v7, v6, v7, vcc
	v_lshrrev_b32 v8, 7, v7
	v_lshl_add_u32 v7, v8, 4, v7
	v_add_u32 v8, 576, v6
	v_cmp_eq_u32 vcc, 2, v5
	s_nop 1
	v_cndmask_b32 v7, v7, v8, vcc
	v_add_u32 v8, 836, v6
	v_cmp_eq_u32 vcc, 3, v5
	s_nop 1
	v_cndmask_b32 v7, v7, v8, vcc
	v_lshlrev_b32 v7, 2, v7
	v_add_u32 v150, 126976, v7
	v_add_u32 v6, 32, v4
	v_sub_u32 v7, 0x200, v6
	v_cmp_eq_u32 vcc, 0, v6
	v_mov_b32 v8, 0x100
	s_nop 0
	v_cndmask_b32 v7, v7, v8, vcc
	v_cmp_eq_u32 vcc, 1, v5
	s_nop 1
	v_cndmask_b32 v7, v6, v7, vcc
	v_lshrrev_b32 v8, 7, v7
	v_lshl_add_u32 v7, v8, 4, v7
	v_add_u32 v8, 576, v6
	v_cmp_eq_u32 vcc, 2, v5
	s_nop 1
	v_cndmask_b32 v7, v7, v8, vcc
	v_add_u32 v8, 836, v6
	v_cmp_eq_u32 vcc, 3, v5
	s_nop 1
	v_cndmask_b32 v7, v7, v8, vcc
	v_lshlrev_b32 v7, 2, v7
	v_add_u32 v151, 126976, v7
	v_add_u32 v6, 48, v4
	v_sub_u32 v7, 0x200, v6
	v_cmp_eq_u32 vcc, 0, v6
	v_mov_b32 v8, 0x100
	s_nop 0
	v_cndmask_b32 v7, v7, v8, vcc
	v_cmp_eq_u32 vcc, 1, v5
	s_nop 1
	v_cndmask_b32 v7, v6, v7, vcc
	v_lshrrev_b32 v8, 7, v7
	v_lshl_add_u32 v7, v8, 4, v7
	v_add_u32 v8, 576, v6
	v_cmp_eq_u32 vcc, 2, v5
	s_nop 1
	v_cndmask_b32 v7, v7, v8, vcc
	v_add_u32 v8, 836, v6
	v_cmp_eq_u32 vcc, 3, v5
	s_nop 1
	v_cndmask_b32 v7, v7, v8, vcc
	v_lshlrev_b32 v7, 2, v7
	v_add_u32 v152, 126976, v7
	v_cvt_f32_u32 v4, v2
	v_mul_f32 v4, 0x3b000000, v4
	v_lshlrev_b32 v5, 3, v3
	v_cvt_f32_u32 v5, v5
	v_mul_f32 v6, v5, v4
	v_add_f32 v7, v6, v4
	s_mov_b32 s58, 0x05040100
	s_mov_b32 s59, 0x07060302
	v_cos_f32 v128, v6
	v_sin_f32 v132, v6
	v_fmamk_f32 v133, v4, 0x40000000, v6
	v_fmamk_f32 v134, v4, 0x40800000, v6
	v_fmamk_f32 v135, v4, 0x40c00000, v6
	v_cos_f32 v129, v133
	v_sin_f32 v133, v133
	v_cos_f32 v130, v134
	v_sin_f32 v134, v134
	v_cos_f32 v131, v135
	v_sin_f32 v135, v135
	v_cos_f32 v136, v7
	v_sin_f32 v140, v7
	v_fmamk_f32 v141, v4, 0x40000000, v7
	v_fmamk_f32 v142, v4, 0x40800000, v7
	v_fmamk_f32 v143, v4, 0x40c00000, v7
	v_cos_f32 v137, v141
	v_sin_f32 v141, v141
	v_cos_f32 v138, v142
	v_sin_f32 v142, v142
	v_cos_f32 v139, v143
	v_sin_f32 v143, v143
	s_lshl_b32 s36, s3, 10
	s_add_u32 s62, s26, s36
	s_addc_u32 s63, s27, 0
	s_add_u32 m0, s36, 147456
	s_nop 0
	global_load_lds_dwordx4 v21, s[62:63]
	s_add_u32 s62, s26, s36
	s_addc_u32 s63, s27, 0
	s_add_u32 s62, s62, 4096
	s_addc_u32 s63, s63, 0
	s_add_u32 m0, s36, 151552
	s_nop 0
	global_load_lds_dwordx4 v21, s[62:63]
	s_cmp_ge_u32 s3, 2
	s_cbranch_scc1 L_2
	s_add_u32 s62, s26, s36
	s_addc_u32 s63, s27, 0
	s_add_u32 s62, s62, 8192
	s_addc_u32 s63, s63, 0
	s_add_u32 m0, s36, 155648
	s_nop 0
	global_load_lds_dwordx4 v21, s[62:63]
L_2:
	global_load_dwordx2 v[32:33], v145, s[34:35]
	global_load_dwordx2 v[34:35], v145, s[40:41]
	global_load_dwordx2 v[36:37], v145, s[42:43]
	global_load_dwordx2 v[38:39], v145, s[54:55]
	global_load_ushort v40, v146, s[6:7]
	global_load_ushort v41, v146, s[8:9]
	global_load_ushort v42, v147, s[6:7]
	global_load_ushort v43, v147, s[8:9]
	s_and_b32 s38, s3, 1
	s_lshr_b32 s39, s3, 1
	s_cmp_eq_u32 s39, 0
	s_cselect_b32 s56, 0x80000000, 0
	v_lshlrev_b32 v4, 1, v2
	v_add_u32 v4, s38, v4
	v_cvt_f32_u32 v5, v4
	v_mul_f32 v5, 0x3a800000, v5
	v_lshlrev_b32 v6, 3, v3
	s_xor_b32 s37, s38, 0
	v_add_u32 v7, s37, v6
	v_cvt_f32_u32 v7, v7
	v_mul_f32 v7, v7, v5
	v_cos_f32 v156, v7
	v_sin_f32 v160, v7
	v_fmamk_f32 v161, v5, 0x40000000, v7
	v_fmamk_f32 v162, v5, 0x40800000, v7
	v_fmamk_f32 v163, v5, 0x40c00000, v7
	v_cos_f32 v157, v161
	v_sin_f32 v161, v161
	v_cos_f32 v158, v162
	v_sin_f32 v162, v162
	v_cos_f32 v159, v163
	v_sin_f32 v163, v163
	v_accvgpr_write_b32 a96, v156
	v_accvgpr_write_b32 a97, v157
	v_accvgpr_write_b32 a98, v158
	v_accvgpr_write_b32 a99, v159
	v_accvgpr_write_b32 a100, v160
	v_accvgpr_write_b32 a101, v161
	v_accvgpr_write_b32 a102, v162
	v_accvgpr_write_b32 a103, v163
	s_xor_b32 s37, s38, 1
	v_add_u32 v7, s37, v6
	v_cvt_f32_u32 v7, v7
	v_mul_f32 v7, v7, v5
	v_cos_f32 v156, v7
	v_sin_f32 v160, v7
	v_fmamk_f32 v161, v5, 0x40000000, v7
	v_fmamk_f32 v162, v5, 0x40800000, v7
	v_fmamk_f32 v163, v5, 0x40c00000, v7
	v_cos_f32 v157, v161
	v_sin_f32 v161, v161
	v_cos_f32 v158, v162
	v_sin_f32 v162, v162
	v_cos_f32 v159, v163
	v_sin_f32 v163, v163
	v_accvgpr_write_b32 a104, v156
	v_accvgpr_write_b32 a105, v157
	v_accvgpr_write_b32 a106, v158
	v_accvgpr_write_b32 a107, v159
	v_accvgpr_write_b32 a108, v160
	v_accvgpr_write_b32 a109, v161
	v_accvgpr_write_b32 a110, v162
	v_accvgpr_write_b32 a111, v163
	v_add_u32 v6, s38, v6
	v_cvt_f32_u32 v6, v6
	s_xor_b32 s37, s38, 0
	v_lshlrev_b32 v5, 1, v2
	v_add_u32 v5, s37, v5
	v_cvt_f32_u32 v5, v5
	v_mul_f32 v5, 0x3a800000, v5
	v_mul_f32 v7, v6, v5
	v_cos_f32 v156, v7
	v_sin_f32 v160, v7
	v_fmamk_f32 v161, v5, 0x40000000, v7
	v_fmamk_f32 v162, v5, 0x40800000, v7
	v_fmamk_f32 v163, v5, 0x40c00000, v7
	v_cos_f32 v157, v161
	v_sin_f32 v161, v161
	v_cos_f32 v158, v162
	v_sin_f32 v162, v162
	v_cos_f32 v159, v163
	v_sin_f32 v163, v163
	v_accvgpr_write_b32 a112, v156
	v_accvgpr_write_b32 a113, v157
	v_accvgpr_write_b32 a114, v158
	v_accvgpr_write_b32 a115, v159
	v_accvgpr_write_b32 a116, v160
	v_accvgpr_write_b32 a117, v161
	v_accvgpr_write_b32 a118, v162
	v_accvgpr_write_b32 a119, v163
	s_xor_b32 s37, s38, 1
	v_lshlrev_b32 v5, 1, v2
	v_add_u32 v5, s37, v5
	v_cvt_f32_u32 v5, v5
	v_mul_f32 v5, 0x3a800000, v5
	v_mul_f32 v7, v6, v5
	v_cos_f32 v156, v7
	v_sin_f32 v160, v7
	v_fmamk_f32 v161, v5, 0x40000000, v7
	v_fmamk_f32 v162, v5, 0x40800000, v7
	v_fmamk_f32 v163, v5, 0x40c00000, v7
	v_cos_f32 v157, v161
	v_sin_f32 v161, v161
	v_cos_f32 v158, v162
	v_sin_f32 v162, v162
	v_cos_f32 v159, v163
	v_sin_f32 v163, v163
	v_accvgpr_write_b32 a120, v156
	v_accvgpr_write_b32 a121, v157
	v_accvgpr_write_b32 a122, v158
	v_accvgpr_write_b32 a123, v159
	v_accvgpr_write_b32 a124, v160
	v_accvgpr_write_b32 a125, v161
	v_accvgpr_write_b32 a126, v162
	v_accvgpr_write_b32 a127, v163
	v_mov_b32 v5, 0x3d000000
	s_xor_b32 s37, s38, 0
	v_lshlrev_b32 v7, 3, v3
	v_add_u32 v7, s37, v7
	v_lshlrev_b32 v7, 5, v7
	v_add_u32 v7, v7, v4
	v_cvt_f32_u32 v7, v7
	v_mul_f32 v7, 0x3a000000, v7
	v_cos_f32 v168, v7
	v_sin_f32 v172, v7
	v_fmamk_f32 v173, v5, 0x3f800000, v7
	v_fmamk_f32 v174, v5, 0x40000000, v7
	v_fmamk_f32 v175, v5, 0x40400000, v7
	v_cos_f32 v169, v173
	v_sin_f32 v173, v173
	v_cos_f32 v170, v174
	v_sin_f32 v174, v174
	v_cos_f32 v171, v175
	v_sin_f32 v175, v175
	s_xor_b32 s37, s38, 1
	v_lshlrev_b32 v7, 3, v3
	v_add_u32 v7, s37, v7
	v_lshlrev_b32 v7, 5, v7
	v_add_u32 v7, v7, v4
	v_cvt_f32_u32 v7, v7
	v_mul_f32 v7, 0x3a000000, v7
	v_cos_f32 v176, v7
	v_sin_f32 v180, v7
	v_fmamk_f32 v181, v5, 0x3f800000, v7
	v_fmamk_f32 v182, v5, 0x40000000, v7
	v_fmamk_f32 v183, v5, 0x40400000, v7
	v_cos_f32 v177, v181
	v_sin_f32 v181, v181
	v_cos_f32 v178, v182
	v_sin_f32 v182, v182
	v_cos_f32 v179, v183
	v_sin_f32 v183, v183
	v_xor_b32 v168, s56, v168
	v_xor_b32 v169, s56, v169
	v_xor_b32 v170, s56, v170
	v_xor_b32 v171, s56, v171
	v_xor_b32 v172, s56, v172
	v_xor_b32 v173, s56, v173
	v_xor_b32 v174, s56, v174
	v_xor_b32 v175, s56, v175
	v_xor_b32 v176, s56, v176
	v_xor_b32 v177, s56, v177
	v_xor_b32 v178, s56, v178
	v_xor_b32 v179, s56, v179
	v_xor_b32 v180, s56, v180
	v_xor_b32 v181, s56, v181
	v_xor_b32 v182, s56, v182
	v_xor_b32 v183, s56, v183
	s_lshl_b32 s37, s3, 12
	s_add_u32 s37, s37, 145408
	s_cmp_lg_u32 s2, 0
	s_cbranch_scc1 L_3
	s_xor_b32 s39, s38, 0
	s_add_u32 s39, s39, 0
	v_lshlrev_b32 v4, 3, v3
	v_add_u32 v4, s39, v4
	v_lshlrev_b32 v4, 5, v4
	v_lshl_add_u32 v4, v2, 1, v4
	v_add_u32 v4, s38, v4
	v_sub_u32 v4, 0x400, v4
	v_and_b32 v4, 0x3ff, v4
	v_bfe_u32 v5, v4, 1, 4
	v_lshrrev_b32 v6, 8, v4
	v_lshl_add_u32 v5, v6, 4, v5
	v_lshlrev_b32 v5, 4, v5
	v_bfe_u32 v6, v4, 6, 2
	v_lshl_add_u32 v5, v6, 2, v5
	v_bfe_u32 v6, v4, 5, 1
	v_xor_b32 v6, s38, v6
	v_lshl_add_u32 v5, v6, 11, v5
	v_add_u32 v200, s37, v5
	s_xor_b32 s39, s38, 0
	s_add_u32 s39, s39, 2
	v_lshlrev_b32 v4, 3, v3
	v_add_u32 v4, s39, v4
	v_lshlrev_b32 v4, 5, v4
	v_lshl_add_u32 v4, v2, 1, v4
	v_add_u32 v4, s38, v4
	v_sub_u32 v4, 0x400, v4
	v_and_b32 v4, 0x3ff, v4
	v_bfe_u32 v5, v4, 1, 4
	v_lshrrev_b32 v6, 8, v4
	v_lshl_add_u32 v5, v6, 4, v5
	v_lshlrev_b32 v5, 4, v5
	v_bfe_u32 v6, v4, 6, 2
	v_lshl_add_u32 v5, v6, 2, v5
	v_bfe_u32 v6, v4, 5, 1
	v_xor_b32 v6, s38, v6
	v_lshl_add_u32 v5, v6, 11, v5
	v_add_u32 v201, s37, v5
	s_xor_b32 s39, s38, 0
	s_add_u32 s39, s39, 4
	v_lshlrev_b32 v4, 3, v3
	v_add_u32 v4, s39, v4
	v_lshlrev_b32 v4, 5, v4
	v_lshl_add_u32 v4, v2, 1, v4
	v_add_u32 v4, s38, v4
	v_sub_u32 v4, 0x400, v4
	v_and_b32 v4, 0x3ff, v4
	v_bfe_u32 v5, v4, 1, 4
	v_lshrrev_b32 v6, 8, v4
	v_lshl_add_u32 v5, v6, 4, v5
	v_lshlrev_b32 v5, 4, v5
	v_bfe_u32 v6, v4, 6, 2
	v_lshl_add_u32 v5, v6, 2, v5
	v_bfe_u32 v6, v4, 5, 1
	v_xor_b32 v6, s38, v6
	v_lshl_add_u32 v5, v6, 11, v5
	v_add_u32 v202, s37, v5
	s_xor_b32 s39, s38, 0
	s_add_u32 s39, s39, 6
	v_lshlrev_b32 v4, 3, v3
	v_add_u32 v4, s39, v4
	v_lshlrev_b32 v4, 5, v4
	v_lshl_add_u32 v4, v2, 1, v4
	v_add_u32 v4, s38, v4
	v_sub_u32 v4, 0x400, v4
	v_and_b32 v4, 0x3ff, v4
	v_bfe_u32 v5, v4, 1, 4
	v_lshrrev_b32 v6, 8, v4
	v_lshl_add_u32 v5, v6, 4, v5
	v_lshlrev_b32 v5, 4, v5
	v_bfe_u32 v6, v4, 6, 2
	v_lshl_add_u32 v5, v6, 2, v5
	v_bfe_u32 v6, v4, 5, 1
	v_xor_b32 v6, s38, v6
	v_lshl_add_u32 v5, v6, 11, v5
	v_add_u32 v203, s37, v5
	s_xor_b32 s39, s38, 1
	s_add_u32 s39, s39, 0
	v_lshlrev_b32 v4, 3, v3
	v_add_u32 v4, s39, v4
	v_lshlrev_b32 v4, 5, v4
	v_lshl_add_u32 v4, v2, 1, v4
	v_add_u32 v4, s38, v4
	v_sub_u32 v4, 0x400, v4
	v_and_b32 v4, 0x3ff, v4
	v_bfe_u32 v5, v4, 1, 4
	v_lshrrev_b32 v6, 8, v4
	v_lshl_add_u32 v5, v6, 4, v5
	v_lshlrev_b32 v5, 4, v5
	v_bfe_u32 v6, v4, 6, 2
	v_lshl_add_u32 v5, v6, 2, v5
	v_bfe_u32 v6, v4, 5, 1
	v_xor_b32 v6, s38, v6
	v_lshl_add_u32 v5, v6, 11, v5
	v_add_u32 v204, s37, v5
	s_xor_b32 s39, s38, 1
	s_add_u32 s39, s39, 2
	v_lshlrev_b32 v4, 3, v3
	v_add_u32 v4, s39, v4
	v_lshlrev_b32 v4, 5, v4
	v_lshl_add_u32 v4, v2, 1, v4
	v_add_u32 v4, s38, v4
	v_sub_u32 v4, 0x400, v4
	v_and_b32 v4, 0x3ff, v4
	v_bfe_u32 v5, v4, 1, 4
	v_lshrrev_b32 v6, 8, v4
	v_lshl_add_u32 v5, v6, 4, v5
	v_lshlrev_b32 v5, 4, v5
	v_bfe_u32 v6, v4, 6, 2
	v_lshl_add_u32 v5, v6, 2, v5
	v_bfe_u32 v6, v4, 5, 1
	v_xor_b32 v6, s38, v6
	v_lshl_add_u32 v5, v6, 11, v5
	v_add_u32 v205, s37, v5
	s_xor_b32 s39, s38, 1
	s_add_u32 s39, s39, 4
	v_lshlrev_b32 v4, 3, v3
	v_add_u32 v4, s39, v4
	v_lshlrev_b32 v4, 5, v4
	v_lshl_add_u32 v4, v2, 1, v4
	v_add_u32 v4, s38, v4
	v_sub_u32 v4, 0x400, v4
	v_and_b32 v4, 0x3ff, v4
	v_bfe_u32 v5, v4, 1, 4
	v_lshrrev_b32 v6, 8, v4
	v_lshl_add_u32 v5, v6, 4, v5
	v_lshlrev_b32 v5, 4, v5
	v_bfe_u32 v6, v4, 6, 2
	v_lshl_add_u32 v5, v6, 2, v5
	v_bfe_u32 v6, v4, 5, 1
	v_xor_b32 v6, s38, v6
	v_lshl_add_u32 v5, v6, 11, v5
	v_add_u32 v206, s37, v5
	s_xor_b32 s39, s38, 1
	s_add_u32 s39, s39, 6
	v_lshlrev_b32 v4, 3, v3
	v_add_u32 v4, s39, v4
	v_lshlrev_b32 v4, 5, v4
	v_lshl_add_u32 v4, v2, 1, v4
	v_add_u32 v4, s38, v4
	v_sub_u32 v4, 0x400, v4
	v_and_b32 v4, 0x3ff, v4
	v_bfe_u32 v5, v4, 1, 4
	v_lshrrev_b32 v6, 8, v4
	v_lshl_add_u32 v5, v6, 4, v5
	v_lshlrev_b32 v5, 4, v5
	v_bfe_u32 v6, v4, 6, 2
	v_lshl_add_u32 v5, v6, 2, v5
	v_bfe_u32 v6, v4, 5, 1
	v_xor_b32 v6, s38, v6
	v_lshl_add_u32 v5, v6, 11, v5
	v_add_u32 v207, s37, v5
L_3:
	s_waitcnt vmcnt(16)
	v_dot2_f32_bf16 v112, v24, v22, 0
	v_dot2_f32_bf16 v113, v24, v24, 0
	v_dot2_f32_bf16 v114, v28, v22, 0
	v_dot2_f32_bf16 v115, v28, v28, 0
	v_dot2_f32_bf16 v112, v25, v22, v112
	v_dot2_f32_bf16 v113, v25, v25, v113
	v_dot2_f32_bf16 v114, v29, v22, v114
	v_dot2_f32_bf16 v115, v29, v29, v115
	v_dot2_f32_bf16 v112, v26, v22, v112
	v_dot2_f32_bf16 v113, v26, v26, v113
	v_dot2_f32_bf16 v114, v30, v22, v114
	v_dot2_f32_bf16 v115, v30, v30, v115
	v_dot2_f32_bf16 v112, v27, v22, v112
	v_dot2_f32_bf16 v113, v27, v27, v113
	v_dot2_f32_bf16 v114, v31, v22, v114
	v_dot2_f32_bf16 v115, v31, v31, v115
	v_lshlrev_b32 v48, 16, v24
	v_and_b32 v49, 0xffff0000, v24
	v_lshlrev_b32 v50, 16, v25
	v_and_b32 v51, 0xffff0000, v25
	v_lshlrev_b32 v52, 16, v26
	v_and_b32 v53, 0xffff0000, v26
	v_lshlrev_b32 v54, 16, v27
	v_and_b32 v55, 0xffff0000, v27
	v_lshlrev_b32 v56, 16, v28
	v_and_b32 v57, 0xffff0000, v28
	v_lshlrev_b32 v58, 16, v29
	v_and_b32 v59, 0xffff0000, v29
	v_lshlrev_b32 v60, 16, v30
	v_and_b32 v61, 0xffff0000, v30
	v_lshlrev_b32 v62, 16, v31
	v_and_b32 v63, 0xffff0000, v31
	s_lshr_b32 s36, s2, 3
	s_lshl_b32 s36, s36, 5
	v_bfe_u32 v184, v0, 2, 5
	v_add_u32 v184, s36, v184
	v_lshrrev_b32 v185, 8, v184
	v_and_b32 v184, 255, v184
	v_lshl_add_u32 v184, v185, 9, v184
	v_mul_u32_u24 v184, 2752, v184
	v_and_b32 v185, 3, v0
	v_lshlrev_b32 v185, 7, v185
	v_min_u32 v185, 380, v185
	s_and_b32 s36, s2, 7
	s_mul_i32 s36, s36, 384
	v_add_u32 v185, s36, v185
	v_min_u32 v185, 2748, v185
	v_add_u32 v184, v184, v185
	s_cmp_lt_u32 s3, 2
	s_cselect_b32 s36, -1, 0
	v_and_b32 v184, s36, v184
	global_load_dword v23, v184, s[12:13]
	v_permlane32_swap_b32 v112, v114
	v_permlane32_swap_b32 v113, v115
	v_add_f32 v116, v112, v114
	v_add_f32 v117, v113, v115
	s_nop 1
	v_permlane16_swap_b32 v116, v117
	v_add_f32 v116, v116, v117
	s_nop 1
	v_add_f32_dpp v116, v116, v116 quad_perm:[1,0,3,2] row_mask:0xf bank_mask:0xf
	s_nop 1
	v_add_f32_dpp v116, v116, v116 quad_perm:[2,3,0,1] row_mask:0xf bank_mask:0xf
	s_nop 1
	v_add_f32_dpp v116, v116, v116 row_half_mirror row_mask:0xf bank_mask:0xf
	s_nop 1
	v_add_f32_dpp v116, v116, v116 row_mirror row_mask:0xf bank_mask:0xf
	v_mov_b32 v117, v116
	s_nop 1
	v_permlane16_swap_b32 v116, v117
	v_mul_f32 v116, 0x3b000000, v116
	v_mul_f32 v117, 0x3b000000, v117
	v_fma_f32 v117, -v116, v116, v117
	v_max_f32 v117, 0, v117
	v_cvt_pk_bf16_f32 v116, v116, v117
	v_and_b32 v117, 0xffff0000, v116
	v_lshlrev_b32 v116, 16, v116
	v_add_f32 v117, 0x3727c5ac, v117
	v_readlane_b32 s46, v116, 0
	v_readlane_b32 s47, v116, 32
	v_cvt_pk_bf16_f32 v117, v117, v117
	v_lshlrev_b32 v117, 16, v117
	v_sqrt_f32 v117, v117
	s_nop 0
	v_cvt_pk_bf16_f32 v117, v117, v117
	v_lshlrev_b32 v117, 16, v117
	v_rcp_f32 v117, v117
	s_nop 0
	v_readlane_b32 s48, v117, 0
	v_readlane_b32 s49, v117, 32
	s_lshr_b32 s36, s2, 3
	s_mul_i32 s36, s36, 16
	v_min_u32 v184, 15, v0
	v_add_u32 v184, s36, v184
	v_lshrrev_b32 v185, 2, v184
	v_mul_u32_u24 v186, 0x40000, v185
	v_lshrrev_b32 v186, 23, v186
	v_mul_u32_u24 v186, 320, v186
	v_add_u32 v185, v186, v185
	v_add_u32 v185, 0, v185
	v_and_b32 v184, 3, v184
	v_min_u32 v185, 0x55f, v185
	v_lshlrev_b32 v185, 12, v185
	v_lshl_add_u32 v184, v184, 7, v185
	s_and_b32 s36, s2, 7
	s_lshl_b32 s36, s36, 9
	v_add_u32 v184, s36, v184
	global_load_dword v23, v184, s[16:17]
	v_subrev_f32 v48, s46, v48
	v_subrev_f32 v49, s46, v49
	v_subrev_f32 v50, s46, v50
	v_subrev_f32 v51, s46, v51
	v_subrev_f32 v52, s46, v52
	v_subrev_f32 v53, s46, v53
	v_subrev_f32 v54, s46, v54
	v_subrev_f32 v55, s46, v55
	v_cvt_pk_bf16_f32 v112, v48, v49
	v_cvt_pk_bf16_f32 v113, v50, v51
	v_cvt_pk_bf16_f32 v114, v52, v53
	v_cvt_pk_bf16_f32 v115, v54, v55
	v_lshlrev_b32 v48, 16, v112
	v_and_b32 v49, 0xffff0000, v112
	v_lshlrev_b32 v50, 16, v113
	v_and_b32 v51, 0xffff0000, v113
	v_lshlrev_b32 v52, 16, v114
	v_and_b32 v53, 0xffff0000, v114
	v_lshlrev_b32 v54, 16, v115
	v_and_b32 v55, 0xffff0000, v115
	v_mul_f32 v48, s48, v48
	v_mul_f32 v49, s48, v49
	v_mul_f32 v50, s48, v50
	v_mul_f32 v51, s48, v51
	v_mul_f32 v52, s48, v52
	v_mul_f32 v53, s48, v53
	v_mul_f32 v54, s48, v54
	v_mul_f32 v55, s48, v55
	s_lshl_b32 s36, s96, 1
	v_and_b32 v184, 1, v0
	v_mul_u32_u24 v184, 92, v184
	v_add_u32 v184, s36, v184
	s_lshr_b32 s36, s2, 3
	s_lshl_b32 s36, s36, 7
	v_mov_b32 v185, s36
	global_load_dword v23, v184, s[14:15]
	global_load_dword v23, v185, s[18:19]
	v_subrev_f32 v56, s47, v56
	v_subrev_f32 v57, s47, v57
	v_subrev_f32 v58, s47, v58
	v_subrev_f32 v59, s47, v59
	v_subrev_f32 v60, s47, v60
	v_subrev_f32 v61, s47, v61
	v_subrev_f32 v62, s47, v62
	v_subrev_f32 v63, s47, v63
	v_cvt_pk_bf16_f32 v112, v56, v57
	v_cvt_pk_bf16_f32 v113, v58, v59
	v_cvt_pk_bf16_f32 v114, v60, v61
	v_cvt_pk_bf16_f32 v115, v62, v63
	v_lshlrev_b32 v56, 16, v112
	v_and_b32 v57, 0xffff0000, v112
	v_lshlrev_b32 v58, 16, v113
	v_and_b32 v59, 0xffff0000, v113
	v_lshlrev_b32 v60, 16, v114
	v_and_b32 v61, 0xffff0000, v114
	v_lshlrev_b32 v62, 16, v115
	v_and_b32 v63, 0xffff0000, v115
	v_mul_f32 v56, s49, v56
	v_mul_f32 v57, s49, v57
	v_mul_f32 v58, s49, v58
	v_mul_f32 v59, s49, v59
	v_mul_f32 v60, s49, v60
	v_mul_f32 v61, s49, v61
	v_mul_f32 v62, s49, v62
	v_mul_f32 v63, s49, v63
	s_lshl_b32 s36, s2, 2
	s_add_u32 s36, s36, s3
	s_lshl_b32 s36, s36, 11
	v_mov_b32 v184, s36
	global_load_dword v23, v184, s[20:21]
	s_waitcnt vmcnt(13)
	s_waitcnt lgkmcnt(0)
	s_add_u32 s10, s10, 0x7F4A7C15
	s_addc_u32 s11, s11, 0x9E3779B9
	s_barrier
	s_cmp_lg_u32 s3, 0
	s_cbranch_scc1 L_4
	s_lshl_b32 s45, s2, 4
	s_add_u32 s45, s45, 13635584
	v_mov_b32 v4, s45
	v_mov_b32 v6, s10
	v_mov_b32 v7, s11
	s_mov_b64 exec, 1
	global_store_dwordx2 v4, v[6:7], s[24:25] sc1
	s_mov_b64 exec, -1
L_4:
	v_add_u32 v5, 147456, v21
	ds_read_b128 v[216:219], v5 offset:8192
	ds_read_b128 v[220:223], v5 offset:9216
	ds_read_b128 v[224:227], v5 offset:0
	ds_read_b128 v[228:231], v5 offset:1024
	ds_read_b128 v[232:235], v5 offset:2048
	ds_read_b128 v[236:239], v5 offset:3072
	ds_read_b128 v[240:243], v5 offset:4096
	ds_read_b128 v[244:247], v5 offset:5120
	ds_read_b128 v[248:251], v5 offset:6144
	ds_read_b128 v[252:255], v5 offset:7168
	v_cvt_pk_bf16_f32 v64, v48, v56
	v_cvt_pk_bf16_f32 v68, v49, v57
	v_cvt_pk_bf16_f32 v65, v50, v58
	v_cvt_pk_bf16_f32 v69, v51, v59
	v_cvt_pk_bf16_f32 v66, v52, v60
	v_cvt_pk_bf16_f32 v70, v53, v61
	v_cvt_pk_bf16_f32 v67, v54, v62
	v_cvt_pk_bf16_f32 v71, v55, v63
	s_waitcnt lgkmcnt(8)
	v_mfma_f32_16x16x32_bf16 v[72:75], v[64:67], v[216:219], 0
	v_mfma_f32_16x16x32_bf16 v[76:79], v[64:67], v[220:223], 0
	v_mfma_f32_16x16x32_bf16 v[80:83], v[68:71], v[216:219], 0
	v_mfma_f32_16x16x32_bf16 v[84:87], v[68:71], v[220:223], 0
	s_waitcnt vmcnt(5)
	v_perm_b32 v44, v34, v32, s58
	v_perm_b32 v45, v34, v32, s59
	v_perm_b32 v46, v35, v33, s58
	v_perm_b32 v47, v35, v33, s59
	ds_write_b128 v154, v[44:47] offset:2304
	v_perm_b32 v44, v38, v36, s58
	v_perm_b32 v45, v38, v36, s59
	v_perm_b32 v46, v39, v37, s58
	v_perm_b32 v47, v39, v37, s59
	ds_write_b128 v154, v[44:47] offset:3344
	v_lshlrev_b32 v40, 16, v40
	v_lshlrev_b32 v41, 16, v41
	v_lshlrev_b32 v42, 16, v42
	v_lshlrev_b32 v43, 16, v43
	v_add_f32 v40, v40, v42
	v_sub_f32 v41, v41, v43
	v_mul_f32 v40, 0.5, v40
	v_mul_f32 v41, 0.5, v41
	v_cvt_pk_bf16_f32 v40, v40, v41
	s_mov_b64 exec, 15
	ds_write_b32 v155, v40
	s_mov_b64 exec, -1
	v_mul_f32 v112, v72, v128
	v_mul_f32 v116, v76, v128
	v_mul_f32 v113, v73, v129
	v_mul_f32 v117, v77, v129
	v_mul_f32 v114, v74, v130
	v_mul_f32 v118, v78, v130
	v_mul_f32 v115, v75, v131
	v_mul_f32 v119, v79, v131
	v_fmac_f32 v112, v76, v132
	v_fma_f32 v116, -v72, v132, v116
	v_fmac_f32 v113, v77, v133
	v_fma_f32 v117, -v73, v133, v117
	v_fmac_f32 v114, v78, v134
	v_fma_f32 v118, -v74, v134, v118
	v_fmac_f32 v115, v79, v135
	v_fma_f32 v119, -v75, v135, v119
	v_cvt_pk_bf16_f32 v88, v112, v116
	v_cvt_pk_bf16_f32 v89, v113, v117
	v_cvt_pk_bf16_f32 v90, v114, v118
	v_cvt_pk_bf16_f32 v91, v115, v119
	v_mul_f32 v112, v80, v136
	v_mul_f32 v116, v84, v136
	v_mul_f32 v113, v81, v137
	v_mul_f32 v117, v85, v137
	v_mul_f32 v114, v82, v138
	v_mul_f32 v118, v86, v138
	v_mul_f32 v115, v83, v139
	v_mul_f32 v119, v87, v139
	v_fmac_f32 v112, v84, v140
	v_fma_f32 v116, -v80, v140, v116
	v_fmac_f32 v113, v85, v141
	v_fma_f32 v117, -v81, v141, v117
	v_fmac_f32 v114, v86, v142
	v_fma_f32 v118, -v82, v142, v118
	v_fmac_f32 v115, v87, v143
	v_fma_f32 v119, -v83, v143, v119
	v_cvt_pk_bf16_f32 v92, v112, v116
	v_cvt_pk_bf16_f32 v93, v113, v117
	v_cvt_pk_bf16_f32 v94, v114, v118
	v_cvt_pk_bf16_f32 v95, v115, v119
	s_waitcnt lgkmcnt(0)
	v_mfma_f32_16x16x32_bf16 v[96:99], v[224:227], v[88:91], 0
	v_mfma_f32_16x16x32_bf16 v[96:99], v[232:235], v[92:95], v[96:99]
	v_mfma_f32_16x16x32_bf16 v[100:103], v[228:231], v[88:91], 0
	v_mfma_f32_16x16x32_bf16 v[100:103], v[236:239], v[92:95], v[100:103]
	v_mfma_f32_16x16x32_bf16 v[104:107], v[240:243], v[88:91], 0
	v_mfma_f32_16x16x32_bf16 v[104:107], v[248:251], v[92:95], v[104:107]
	v_mfma_f32_16x16x32_bf16 v[108:111], v[244:247], v[88:91], 0
	v_mfma_f32_16x16x32_bf16 v[108:111], v[252:255], v[92:95], v[108:111]
	s_nop 3
	v_cvt_pk_bf16_f32 v112, v96, v100
	ds_write_b32 v148, v112 offset:0
	v_cvt_pk_bf16_f32 v113, v97, v101
	ds_write_b32 v148, v113 offset:128
	v_cvt_pk_bf16_f32 v114, v98, v102
	ds_write_b32 v148, v114 offset:256
	v_cvt_pk_bf16_f32 v115, v99, v103
	ds_write_b32 v148, v115 offset:384
	v_cvt_pk_bf16_f32 v116, v104, v108
	ds_write_b32 v148, v116 offset:64
	v_cvt_pk_bf16_f32 v117, v105, v109
	ds_write_b32 v148, v117 offset:192
	v_cvt_pk_bf16_f32 v118, v106, v110
	ds_write_b32 v148, v118 offset:320
	v_cvt_pk_bf16_f32 v119, v107, v111
	ds_write_b32 v148, v119 offset:448
	s_waitcnt lgkmcnt(0)
	s_barrier
	s_cmp_lg_u32 s3, 0
	s_cbranch_scc1 L_5
	v_mul_u32_u24 v4, 1040, v1
	v_add_u32 v4, 130304, v4
	s_mov_b64 exec, 3
	ds_read_b32 v72, v4 offset:0
	ds_read_b32 v73, v4 offset:4384
	ds_read_b32 v74, v4 offset:8768
	ds_read_b32 v75, v4 offset:13152
	s_add_u32 s34, s50, 16416
	s_addc_u32 s35, s51, 0
	s_waitcnt lgkmcnt(0)
	global_store_dwordx4 v21, v[72:75], s[34:35] sc1
	s_mov_b64 exec, -1
L_5:
	ds_read_b32 v48, v149 offset:0
	ds_read_b32 v49, v149 offset:4384
	ds_read_b32 v50, v149 offset:8768
	ds_read_b32 v51, v149 offset:13152
	ds_read_b32 v52, v150 offset:0
	ds_read_b32 v53, v150 offset:4384
	ds_read_b32 v54, v150 offset:8768
	ds_read_b32 v55, v150 offset:13152
	ds_read_b32 v56, v151 offset:0
	ds_read_b32 v57, v151 offset:4384
	ds_read_b32 v58, v151 offset:8768
	ds_read_b32 v59, v151 offset:13152
	ds_read_b32 v60, v152 offset:0
	ds_read_b32 v61, v152 offset:4384
	ds_read_b32 v62, v152 offset:8768
	ds_read_b32 v63, v152 offset:13152
	v_lshlrev_b32 v194, 4, v0
	v_add_u32 v194, 13635584, v194
	global_load_dwordx2 v[208:209], v194, s[24:25] sc1
	s_waitcnt lgkmcnt(12)
	v_xor_b32 v48, v153, v48
	v_xor_b32 v49, v153, v49
	v_xor_b32 v50, v153, v50
	v_xor_b32 v51, v153, v51
	global_store_dwordx4 v21, v[48:51], s[50:51] offset:0 sc1
	s_waitcnt lgkmcnt(8)
	v_xor_b32 v52, v153, v52
	v_xor_b32 v53, v153, v53
	v_xor_b32 v54, v153, v54
	v_xor_b32 v55, v153, v55
	global_store_dwordx4 v21, v[52:55], s[50:51] offset:1024 sc1
	s_waitcnt lgkmcnt(4)
	v_xor_b32 v56, v153, v56
	v_xor_b32 v57, v153, v57
	v_xor_b32 v58, v153, v58
	v_xor_b32 v59, v153, v59
	global_store_dwordx4 v21, v[56:59], s[50:51] offset:2048 sc1
	s_waitcnt lgkmcnt(0)
	v_xor_b32 v60, v153, v60
	v_xor_b32 v61, v153, v61
	v_xor_b32 v62, v153, v62
	v_xor_b32 v63, v153, v63
	global_store_dwordx4 v21, v[60:63], s[50:51] offset:3072 sc1
	s_bitcmp1_b32 0x1fbfdeff, s98
	s_cbranch_scc0 Lj_6
	s_mov_b32 m0, s99
	s_nop 0
	global_load_lds_dwordx4 v16, s[64:65]
	s_add_u32 m0, m0, 0x400
	s_nop 0
	global_load_lds_dwordx4 v17, s[64:65]
	s_add_u32 m0, m0, 0x400
	s_nop 0
	global_load_lds_dwordx4 v18, s[64:65]
	s_bitcmp1_b32 0x3fc0ff, s98
	s_cbranch_scc1 Lj3_7
	s_add_u32 m0, m0, 0x400
	s_nop 0
	global_load_lds_dwordx4 v19, s[64:65]
Lj3_7:
	s_add_u32 s64, s64, s101
	s_addc_u32 s65, s65, 0
	s_add_u32 s99, s99, s0
	s_add_u32 s98, s98, 1
Lj_6:
	s_bitcmp1_b32 0x1fbfdeff, s98
	s_cbranch_scc0 Lj_8
	s_mov_b32 m0, s99
	s_nop 0
	global_load_lds_dwordx4 v16, s[64:65]
	s_add_u32 m0, m0, 0x400
	s_nop 0
	global_load_lds_dwordx4 v17, s[64:65]
	s_add_u32 m0, m0, 0x400
	s_nop 0
	global_load_lds_dwordx4 v18, s[64:65]
	s_bitcmp1_b32 0x3fc0ff, s98
	s_cbranch_scc1 Lj3_9
	s_add_u32 m0, m0, 0x400
	s_nop 0
	global_load_lds_dwordx4 v19, s[64:65]
Lj3_9:
	s_add_u32 s64, s64, s101
	s_addc_u32 s65, s65, 0
	s_add_u32 s99, s99, s0
	s_add_u32 s98, s98, 1
Lj_8:
	s_bitcmp1_b32 0x1fbfdeff, s98
	s_cbranch_scc0 Lj_10
	s_mov_b32 m0, s99
	s_nop 0
	global_load_lds_dwordx4 v16, s[64:65]
	s_add_u32 m0, m0, 0x400
	s_nop 0
	global_load_lds_dwordx4 v17, s[64:65]
	s_add_u32 m0, m0, 0x400
	s_nop 0
	global_load_lds_dwordx4 v18, s[64:65]
	s_bitcmp1_b32 0x3fc0ff, s98
	s_cbranch_scc1 Lj3_11
	s_add_u32 m0, m0, 0x400
	s_nop 0
	global_load_lds_dwordx4 v19, s[64:65]
Lj3_11:
	s_add_u32 s64, s64, s101
	s_addc_u32 s65, s65, 0
	s_add_u32 s99, s99, s0
	s_add_u32 s98, s98, 1
Lj_10:
	s_barrier
	s_and_b32 s30, s2, 7
	s_lshr_b32 s31, s2, 3
	s_lshr_b32 s32, s31, 1
	s_lshl_b32 s32, s32, 3
	s_add_u32 s30, s30, s32
	s_lshl_b32 s30, s30, 1
	s_and_b32 s31, s31, 1
	s_add_u32 s30, s30, s31
	s_lshr_b32 s31, s3, 1
	s_and_b32 s32, s3, 1
	v_lshrrev_b32 v4, 2, v1
	s_lshl_b32 s33, s3, 6
	v_add_u32 v4, s33, v4
	v_mul_u32_u24 v5, 16512, v4
	v_and_b32 v6, 3, v1
	v_lshl_add_u32 v185, v6, 4, v5
	v_and_b32 v8, 1, v6
	v_or_b32 v7, 2, v8
	v_lshl_add_u32 v195, v7, 4, v5
	v_add_u32 v195, 0x4000, v195
	s_lshl_b32 s33, s30, 6
	s_add_u32 s34, s33, 0
	s_add_u32 s40, s24, s34
	s_addc_u32 s41, s25, 0
	s_add_u32 s34, s33, 264192
	s_add_u32 s42, s24, s34
	s_addc_u32 s43, s25, 0
	s_add_u32 s34, s33, 528384
	s_add_u32 s44, s24, s34
	s_addc_u32 s45, s25, 0
	s_add_u32 s34, s33, 792576
	s_add_u32 s46, s24, s34
	s_addc_u32 s47, s25, 0
	v_lshrrev_b32 v5, 1, v4
	v_mul_u32_u24 v5, 144, v5
	v_and_b32 v4, 1, v4
	v_lshl_add_u32 v5, v4, 6, v5
	v_lshl_add_u32 v5, v6, 4, v5
	v_add_u32 v186, 126976, v5
	v_lshlrev_b32 v184, 6, v3
	v_lshl_add_u32 v184, v2, 1, v184
	s_cmp_eq_u32 s32, 0
	s_cbranch_scc1 L_12
	v_swap_b32 v224, v248
	v_swap_b32 v225, v249
	v_swap_b32 v226, v250
	v_swap_b32 v227, v251
	v_swap_b32 v228, v252
	v_swap_b32 v229, v253
	v_swap_b32 v230, v254
	v_swap_b32 v231, v255
	v_swap_b32 v232, v240
	v_swap_b32 v233, v241
	v_swap_b32 v234, v242
	v_swap_b32 v235, v243
	v_swap_b32 v236, v244
	v_swap_b32 v237, v245
	v_swap_b32 v238, v246
	v_swap_b32 v239, v247
L_12:
	v_lshl_add_u32 v4, v3, 5, v2
	v_mul_u32_u24 v4, 144, v4
	s_lshl_b32 s34, s31, 4
	s_add_u32 s34, s34, 126976
	v_add_u32 v187, s34, v4
	s_cmp_eq_u32 s30, 0
	s_cselect_b32 s38, 1, 0
	s_and_b32 s38, s38, s31
	s_mul_i32 s34, s38, -28672
	s_add_u32 s34, s34, 126976
	s_lshl_b32 s35, s32, 6
	s_add_u32 s34, s34, s35
	s_add_u32 s34, s34, 32
	v_add_u32 v188, s34, v4
	s_xor_b32 s34, s32, 0
	s_lshl_b32 s34, s34, 6
	s_xor_b32 s35, s32, 0
	s_mul_i32 s35, s35, 2304
	s_add_u32 s34, s34, s35
	v_add_u32 v196, s34, v187
	s_xor_b32 s34, s32, 0
	s_lshl_b32 s34, s34, 6
	s_xor_b32 s35, s32, 1
	s_mul_i32 s35, s35, 2304
	s_add_u32 s34, s34, s35
	v_add_u32 v197, s34, v187
	s_xor_b32 s34, s32, 1
	s_lshl_b32 s34, s34, 6
	s_xor_b32 s35, s32, 0
	s_mul_i32 s35, s35, 2304
	s_add_u32 s34, s34, s35
	v_add_u32 v198, s34, v187
	s_xor_b32 s34, s32, 1
	s_lshl_b32 s34, s34, 6
	s_xor_b32 s35, s32, 1
	s_mul_i32 s35, s35, 2304
	s_add_u32 s34, s34, s35
	v_add_u32 v199, s34, v187
	s_mul_i32 s35, s32, 2304
	v_add_u32 v187, s35, v188
	s_xor_b32 s35, s32, 1
	s_mul_i32 s35, s35, 2304
	v_add_u32 v188, s35, v188
	s_lshl_b32 s35, s3, 12
	s_add_u32 s35, s35, 145408
	v_add_u32 v189, s35, v21
	s_xor_b32 s39, s3, 2
	s_lshl_b32 s39, s39, 12
	s_add_u32 s39, s39, 145408
	v_add_u32 v190, s39, v21
	s_lshl_b32 s39, s3, 10
	s_add_u32 s39, s39, 126976
	v_add_u32 v191, s39, v21
	s_xor_b32 s39, s3, 1
	s_lshl_b32 s39, s39, 10
	s_add_u32 s39, s39, 126976
	v_add_u32 v192, s39, v21
	v_lshlrev_b32 v193, 5, v1
	s_lshl_b32 s39, s30, 13
	s_lshl_b32 s35, s32, 12
	s_add_u32 s39, s39, s35
	s_lshl_b32 s35, s31, 4
	s_add_u32 s39, s39, s35
	s_lshl_b32 s35, s32, 11
	s_add_u32 s35, s35, s39
	s_add_u32 s52, s24, s35
	s_addc_u32 s53, s25, 0
	s_add_u32 s52, s52, 5242880
	s_addc_u32 s53, s53, 0
	s_xor_b32 s35, s32, 1
	s_lshl_b32 s35, s35, 11
	s_add_u32 s35, s35, s39
	s_add_u32 s54, s24, s35
	s_addc_u32 s55, s25, 0
	s_add_u32 s54, s54, 5242880
	s_addc_u32 s55, s55, 0
	s_cmp_eq_u32 s31, 0
	s_cselect_b32 s56, 0x80000000, 0
	s_cselect_b32 s57, 0, 0x80000000
	v_accvgpr_read_b32 v136, a96
	v_accvgpr_read_b32 v137, a97
	v_accvgpr_read_b32 v138, a98
	v_accvgpr_read_b32 v139, a99
	v_accvgpr_read_b32 v140, a100
	v_accvgpr_read_b32 v141, a101
	v_accvgpr_read_b32 v142, a102
	v_accvgpr_read_b32 v143, a103
	v_accvgpr_read_b32 v144, a104
	v_accvgpr_read_b32 v145, a105
	v_accvgpr_read_b32 v146, a106
	v_accvgpr_read_b32 v147, a107
	v_accvgpr_read_b32 v148, a108
	v_accvgpr_read_b32 v149, a109
	v_accvgpr_read_b32 v150, a110
	v_accvgpr_read_b32 v151, a111
	v_accvgpr_read_b32 v152, a112
	v_accvgpr_read_b32 v153, a113
	v_accvgpr_read_b32 v154, a114
	v_accvgpr_read_b32 v155, a115
	v_accvgpr_read_b32 v156, a116
	v_accvgpr_read_b32 v157, a117
	v_accvgpr_read_b32 v158, a118
	v_accvgpr_read_b32 v159, a119
	v_accvgpr_read_b32 v160, a120
	v_accvgpr_read_b32 v161, a121
	v_accvgpr_read_b32 v162, a122
	v_accvgpr_read_b32 v163, a123
	v_accvgpr_read_b32 v164, a124
	v_accvgpr_read_b32 v165, a125
	v_accvgpr_read_b32 v166, a126
	v_accvgpr_read_b32 v167, a127
	v_cmp_ne_u32 s[36:37], s2, v0
	s_waitcnt vmcnt(13)
	s_mov_b32 s28, 0
L_13:
	v_cmp_ne_u32 vcc, s10, v208
	v_cmp_ne_u32 s[34:35], s11, v209
	s_add_u32 s28, s28, 1
	s_cmp_gt_u32 s28, 20000
	s_cbranch_scc1 L_14
	s_or_b64 vcc, vcc, s[34:35]
	s_and_b64 vcc, vcc, s[36:37]
	s_cbranch_scc0 L_14
	global_load_dwordx2 v[208:209], v194, s[24:25] sc1
	s_waitcnt vmcnt(0)
	s_branch L_13
L_14:
	s_cmp_eq_u32 s30, 0
	s_cbranch_scc1 L_15
	global_load_dwordx4 v[24:27], v185, s[40:41] sc1
	global_load_dwordx4 v[28:31], v185, s[42:43] sc1
	global_load_dwordx4 v[32:35], v185, s[44:45] sc1
	global_load_dwordx4 v[36:39], v185, s[46:47] sc1
	s_branch L_16
L_15:
	global_load_dwordx4 v[24:27], v185, s[40:41] sc1
	global_load_dwordx4 v[28:31], v185, s[42:43] sc1
	global_load_dwordx4 v[32:35], v185, s[44:45] sc1
	global_load_dwordx4 v[36:39], v185, s[46:47] sc1
	global_load_dwordx4 v[40:43], v195, s[40:41] sc1
	global_load_dwordx4 v[44:47], v195, s[42:43] sc1
	global_load_dwordx4 v[48:51], v195, s[44:45] sc1
	global_load_dwordx4 v[52:55], v195, s[46:47] sc1
L_16:
	s_lshl_b32 s58, s2, 13
	s_add_u32 s58, s58, 9437184
	v_lshlrev_b32 v8, 4, v0
	v_add_u32 v8, s58, v8
	v_mov_b32 v4, -1
	v_mov_b32 v5, -1
	v_mov_b32 v6, -1
	v_mov_b32 v7, -1
	global_store_dwordx4 v8, v[4:7], s[24:25] sc1
	v_add_u32 v8, 0x1000, v8
	global_store_dwordx4 v8, v[4:7], s[24:25] sc1
	s_cmp_eq_u32 s30, 0
	s_cbranch_scc1 L_17
	s_mov_b32 s28, 0
	s_waitcnt vmcnt(2)
Lqc_21:
	v_max3_u32 v4, v24, v25, v26
	v_max3_u32 v4, v4, v27, v28
	v_max3_u32 v4, v4, v29, v30
	v_max3_u32 v4, v4, v31, v32
	v_max3_u32 v4, v4, v33, v34
	v_max3_u32 v4, v4, v35, v36
	v_max3_u32 v4, v4, v37, v38
	v_max_u32 v4, v4, v39
	v_cmp_eq_u32 vcc, -1, v4
	s_cbranch_vccz Lqd_20
	s_add_u32 s28, s28, 1
	s_cmp_gt_u32 s28, 20000
	s_cbranch_scc1 Lqd_20
	s_bitcmp1_b32 0x100, s98
	s_cbranch_scc0 Ltr_22
	s_mov_b32 s63, 0
	s_waitcnt vmcnt(0)
	s_branch LT_23
Ltr_22:
	s_mov_b64 exec, vcc
	global_load_dwordx4 v[24:27], v185, s[40:41] sc1
	global_load_dwordx4 v[28:31], v185, s[42:43] sc1
	global_load_dwordx4 v[32:35], v185, s[44:45] sc1
	global_load_dwordx4 v[36:39], v185, s[46:47] sc1
	s_mov_b64 exec, -1
	s_waitcnt vmcnt(0)
	s_branch Lqc_21
Lqd_20:
	ds_write_b128 v186, v[24:27] offset:0
	ds_write_b128 v186, v[28:31] offset:1152
	ds_write_b128 v186, v[32:35] offset:2304
	ds_write_b128 v186, v[36:39] offset:3456
	s_branch L_18
L_17:
	s_mov_b32 s28, 0
	s_waitcnt vmcnt(2)
Lqc_26:
	v_max3_u32 v4, v24, v25, v26
	v_max3_u32 v4, v4, v27, v28
	v_max3_u32 v4, v4, v29, v30
	v_max3_u32 v4, v4, v31, v32
	v_max3_u32 v4, v4, v33, v34
	v_max3_u32 v4, v4, v35, v36
	v_max3_u32 v4, v4, v37, v38
	v_max3_u32 v4, v4, v39, v40
	v_max3_u32 v4, v4, v41, v42
	v_max3_u32 v4, v4, v43, v44
	v_max3_u32 v4, v4, v45, v46
	v_max3_u32 v4, v4, v47, v48
	v_max3_u32 v4, v4, v49, v50
	v_max3_u32 v4, v4, v51, v52
	v_max3_u32 v4, v4, v53, v54
	v_max_u32 v4, v4, v55
	v_cmp_eq_u32 vcc, -1, v4
	s_cbranch_vccz Lqd_25
	s_add_u32 s28, s28, 1
	s_cmp_gt_u32 s28, 20000
	s_cbranch_scc1 Lqd_25
	s_bitcmp1_b32 0x100, s98
	s_cbranch_scc0 Ltr_27
	s_mov_b32 s63, 1
	s_waitcnt vmcnt(0)
	s_branch LT_23
Ltr_27:
	s_mov_b64 exec, vcc
	global_load_dwordx4 v[24:27], v185, s[40:41] sc1
	global_load_dwordx4 v[28:31], v185, s[42:43] sc1
	global_load_dwordx4 v[32:35], v185, s[44:45] sc1
	global_load_dwordx4 v[36:39], v185, s[46:47] sc1
	global_load_dwordx4 v[40:43], v195, s[40:41] sc1
	global_load_dwordx4 v[44:47], v195, s[42:43] sc1
	global_load_dwordx4 v[48:51], v195, s[44:45] sc1
	global_load_dwordx4 v[52:55], v195, s[46:47] sc1
	s_mov_b64 exec, -1
	s_waitcnt vmcnt(0)
	s_branch Lqc_26
Lqd_25:
	v_add_u32 v4, -28672, v186
	ds_write_b128 v186, v[24:27] offset:0
	ds_write_b128 v4, v[40:43] offset:0
	ds_write_b128 v186, v[28:31] offset:1152
	ds_write_b128 v4, v[44:47] offset:1152
	ds_write_b128 v186, v[32:35] offset:2304
	ds_write_b128 v4, v[48:51] offset:2304
	ds_write_b128 v186, v[36:39] offset:3456
	ds_write_b128 v4, v[52:55] offset:3456
L_18:
	s_waitcnt vmcnt(0)
	s_bitcmp1_b32 0xff, s98
	s_cbranch_scc0 Lj_28
	s_mov_b32 m0, s99
	s_nop 0
	global_load_lds_dwordx4 v16, s[64:65]
	s_add_u32 m0, m0, 0x400
	s_nop 0
	global_load_lds_dwordx4 v17, s[64:65]
	s_add_u32 m0, m0, 0x400
	s_nop 0
	global_load_lds_dwordx4 v18, s[64:65]
	s_bitcmp1_b32 0x3fc0ff, s98
	s_cbranch_scc1 Lj3_29
	s_add_u32 m0, m0, 0x400
	s_nop 0
	global_load_lds_dwordx4 v19, s[64:65]
Lj3_29:
	s_add_u32 s64, s64, s101
	s_addc_u32 s65, s65, 0
	s_add_u32 s99, s99, s0
	s_add_u32 s98, s98, 1
Lj_28:
	s_waitcnt lgkmcnt(0)
	s_barrier
	ds_read_b128 v[24:27], v196
	ds_read_b128 v[28:31], v197
	ds_read_b128 v[32:35], v198
	ds_read_b128 v[36:39], v199
	ds_read_b128 v[40:43], v187 offset:0
	ds_read_b128 v[44:47], v187 offset:16
	ds_read_b128 v[48:51], v188 offset:0
	ds_read_b128 v[52:55], v188 offset:16
	s_waitcnt lgkmcnt(4)
	v_mfma_f32_16x16x32_bf16 v[56:59], v[24:27], v[224:227], 0
	v_mfma_f32_16x16x32_bf16 v[56:59], v[28:31], v[232:235], v[56:59]
	v_mfma_f32_16x16x32_bf16 v[60:63], v[24:27], v[228:231], 0
	v_mfma_f32_16x16x32_bf16 v[60:63], v[28:31], v[236:239], v[60:63]
	v_mfma_f32_16x16x32_bf16 v[64:67], v[32:35], v[224:227], 0
	s_bitcmp1_b32 0xff, s98
	s_cbranch_scc0 Lj_30
	s_mov_b32 m0, s99
	s_nop 0
	global_load_lds_dwordx4 v16, s[64:65]
	s_add_u32 m0, m0, 0x400
	s_nop 0
	global_load_lds_dwordx4 v17, s[64:65]
	s_add_u32 m0, m0, 0x400
	s_nop 0
	global_load_lds_dwordx4 v18, s[64:65]
	s_bitcmp1_b32 0x3fc0ff, s98
	s_cbranch_scc1 Lj3_31
	s_add_u32 m0, m0, 0x400
	s_nop 0
	global_load_lds_dwordx4 v19, s[64:65]
Lj3_31:
	s_add_u32 s64, s64, s101
	s_addc_u32 s65, s65, 0
	s_add_u32 s99, s99, s0
	s_add_u32 s98, s98, 1
Lj_30:
	v_mfma_f32_16x16x32_bf16 v[64:67], v[36:39], v[232:235], v[64:67]
	v_mfma_f32_16x16x32_bf16 v[68:71], v[32:35], v[228:231], 0
	v_mfma_f32_16x16x32_bf16 v[68:71], v[36:39], v[236:239], v[68:71]
	v_mul_f32 v124, v56, v136
	v_mul_f32 v128, v60, v136
	v_mul_f32 v125, v57, v137
	v_mul_f32 v129, v61, v137
	v_mul_f32 v126, v58, v138
	v_mul_f32 v130, v62, v138
	v_mul_f32 v127, v59, v139
	v_mul_f32 v131, v63, v139
	v_fmac_f32 v124, v60, v140
	v_fma_f32 v128, -v56, v140, v128
	v_fmac_f32 v125, v61, v141
	v_fma_f32 v129, -v57, v141, v129
	v_fmac_f32 v126, v62, v142
	v_fma_f32 v130, -v58, v142, v130
	v_fmac_f32 v127, v63, v143
	v_fma_f32 v131, -v59, v143, v131
	v_cvt_pk_bf16_f32 v72, v124, v128
	v_cvt_pk_bf16_f32 v73, v125, v129
	v_cvt_pk_bf16_f32 v74, v126, v130
	v_cvt_pk_bf16_f32 v75, v127, v131
	v_mul_f32 v124, v64, v144
	v_mul_f32 v128, v68, v144
	v_mul_f32 v125, v65, v145
	v_mul_f32 v129, v69, v145
	v_mul_f32 v126, v66, v146
	v_mul_f32 v130, v70, v146
	v_mul_f32 v127, v67, v147
	v_mul_f32 v131, v71, v147
	v_fmac_f32 v124, v68, v148
	v_fma_f32 v128, -v64, v148, v128
	v_fmac_f32 v125, v69, v149
	v_fma_f32 v129, -v65, v149, v129
	v_fmac_f32 v126, v70, v150
	v_fma_f32 v130, -v66, v150, v130
	v_fmac_f32 v127, v71, v151
	v_fma_f32 v131, -v67, v151, v131
	s_bitcmp1_b32 0xff, s98
	s_cbranch_scc0 Lj_32
	s_mov_b32 m0, s99
	s_nop 0
	global_load_lds_dwordx4 v16, s[64:65]
	s_add_u32 m0, m0, 0x400
	s_nop 0
	global_load_lds_dwordx4 v17, s[64:65]
	s_add_u32 m0, m0, 0x400
	s_nop 0
	global_load_lds_dwordx4 v18, s[64:65]
	s_bitcmp1_b32 0x3fc0ff, s98
	s_cbranch_scc1 Lj3_33
	s_add_u32 m0, m0, 0x400
	s_nop 0
	global_load_lds_dwordx4 v19, s[64:65]
Lj3_33:
	s_add_u32 s64, s64, s101
	s_addc_u32 s65, s65, 0
	s_add_u32 s99, s99, s0
	s_add_u32 s98, s98, 1
Lj_32:
	v_cvt_pk_bf16_f32 v76, v124, v128
	v_cvt_pk_bf16_f32 v77, v125, v129
	v_cvt_pk_bf16_f32 v78, v126, v130
	v_cvt_pk_bf16_f32 v79, v127, v131
	v_mfma_f32_16x16x32_bf16 v[80:83], v[224:227], v[72:75], 0
	s_nop 0
	v_mfma_f32_16x16x32_bf16 v[80:83], v[232:235], v[76:79], v[80:83]
	v_mfma_f32_16x16x32_bf16 v[84:87], v[228:231], v[72:75], 0
	v_mfma_f32_16x16x32_bf16 v[84:87], v[236:239], v[76:79], v[84:87]
	v_mfma_f32_16x16x32_bf16 v[88:91], v[240:243], v[72:75], 0
	v_mfma_f32_16x16x32_bf16 v[88:91], v[248:251], v[76:79], v[88:91]
	v_mfma_f32_16x16x32_bf16 v[92:95], v[244:247], v[72:75], 0
	v_mfma_f32_16x16x32_bf16 v[92:95], v[252:255], v[76:79], v[92:95]
	s_waitcnt lgkmcnt(0)
	v_lshlrev_b32 v124, 16, v40
	v_and_b32 v125, 0xffff0000, v40
	v_lshlrev_b32 v126, 16, v44
	v_and_b32 v127, 0xffff0000, v44
	v_add_f32 v24, v124, v126
	v_add_f32 v25, v125, v127
	v_sub_f32 v124, v124, v126
	v_sub_f32 v125, v125, v127
	v_fmac_f32 v24, v124, v172
	v_fmac_f32 v25, v125, v172
	v_mul_f32 v26, v125, v168
	v_mul_f32 v27, -v124, v168
	s_bitcmp1_b32 0xff, s98
	s_cbranch_scc0 Lj_34
	s_mov_b32 m0, s99
	s_nop 0
	global_load_lds_dwordx4 v16, s[64:65]
	s_add_u32 m0, m0, 0x400
	s_nop 0
	global_load_lds_dwordx4 v17, s[64:65]
	s_add_u32 m0, m0, 0x400
	s_nop 0
	global_load_lds_dwordx4 v18, s[64:65]
	s_bitcmp1_b32 0x3fc0ff, s98
	s_cbranch_scc1 Lj3_35
	s_add_u32 m0, m0, 0x400
	s_nop 0
	global_load_lds_dwordx4 v19, s[64:65]
Lj3_35:
	s_add_u32 s64, s64, s101
	s_addc_u32 s65, s65, 0
	s_add_u32 s99, s99, s0
	s_add_u32 s98, s98, 1
Lj_34:
	v_lshlrev_b32 v124, 16, v41
	v_and_b32 v125, 0xffff0000, v41
	v_lshlrev_b32 v126, 16, v45
	v_and_b32 v127, 0xffff0000, v45
	v_add_f32 v28, v124, v126
	v_add_f32 v29, v125, v127
	v_sub_f32 v124, v124, v126
	v_sub_f32 v125, v125, v127
	v_fmac_f32 v28, v124, v173
	v_fmac_f32 v29, v125, v173
	v_mul_f32 v30, v125, v169
	v_mul_f32 v31, -v124, v169
	v_lshlrev_b32 v124, 16, v42
	v_and_b32 v125, 0xffff0000, v42
	v_lshlrev_b32 v126, 16, v46
	v_and_b32 v127, 0xffff0000, v46
	v_add_f32 v32, v124, v126
	v_add_f32 v33, v125, v127
	v_sub_f32 v124, v124, v126
	v_sub_f32 v125, v125, v127
	v_fmac_f32 v32, v124, v174
	v_fmac_f32 v33, v125, v174
	v_mul_f32 v34, v125, v170
	v_mul_f32 v35, -v124, v170
	v_lshlrev_b32 v124, 16, v43
	v_and_b32 v125, 0xffff0000, v43
	v_lshlrev_b32 v126, 16, v47
	v_and_b32 v127, 0xffff0000, v47
	v_add_f32 v36, v124, v126
	v_add_f32 v37, v125, v127
	v_sub_f32 v124, v124, v126
	v_sub_f32 v125, v125, v127
	v_fmac_f32 v36, v124, v175
	v_fmac_f32 v37, v125, v175
	v_mul_f32 v38, v125, v171
	v_mul_f32 v39, -v124, v171
	v_lshlrev_b32 v124, 16, v48
	v_and_b32 v125, 0xffff0000, v48
	v_lshlrev_b32 v126, 16, v52
	v_and_b32 v127, 0xffff0000, v52
	v_add_f32 v136, v124, v126
	v_add_f32 v137, v125, v127
	v_sub_f32 v124, v124, v126
	v_sub_f32 v125, v125, v127
	v_fmac_f32 v136, v124, v180
	v_fmac_f32 v137, v125, v180
	v_mul_f32 v138, v125, v176
	v_mul_f32 v139, -v124, v176
	s_bitcmp1_b32 0xff, s98
	s_cbranch_scc0 Lj_36
	s_mov_b32 m0, s99
	s_nop 0
	global_load_lds_dwordx4 v16, s[64:65]
	s_add_u32 m0, m0, 0x400
	s_nop 0
	global_load_lds_dwordx4 v17, s[64:65]
	s_add_u32 m0, m0, 0x400
	s_nop 0
	global_load_lds_dwordx4 v18, s[64:65]
	s_bitcmp1_b32 0x3fc0ff, s98
	s_cbranch_scc1 Lj3_37
	s_add_u32 m0, m0, 0x400
	s_nop 0
	global_load_lds_dwordx4 v19, s[64:65]
Lj3_37:
	s_add_u32 s64, s64, s101
	s_addc_u32 s65, s65, 0
	s_add_u32 s99, s99, s0
	s_add_u32 s98, s98, 1
Lj_36:
	v_lshlrev_b32 v124, 16, v49
	v_and_b32 v125, 0xffff0000, v49
	v_lshlrev_b32 v126, 16, v53
	v_and_b32 v127, 0xffff0000, v53
	v_add_f32 v140, v124, v126
	v_add_f32 v141, v125, v127
	v_sub_f32 v124, v124, v126
	v_sub_f32 v125, v125, v127
	v_fmac_f32 v140, v124, v181
	v_fmac_f32 v141, v125, v181
	v_mul_f32 v142, v125, v177
	v_mul_f32 v143, -v124, v177
	v_lshlrev_b32 v124, 16, v50
	v_and_b32 v125, 0xffff0000, v50
	v_lshlrev_b32 v126, 16, v54
	v_and_b32 v127, 0xffff0000, v54
	v_add_f32 v144, v124, v126
	v_add_f32 v145, v125, v127
	v_sub_f32 v124, v124, v126
	v_sub_f32 v125, v125, v127
	v_fmac_f32 v144, v124, v182
	v_fmac_f32 v145, v125, v182
	v_mul_f32 v146, v125, v178
	v_mul_f32 v147, -v124, v178
	v_lshlrev_b32 v124, 16, v51
	v_and_b32 v125, 0xffff0000, v51
	v_lshlrev_b32 v126, 16, v55
	v_and_b32 v127, 0xffff0000, v55
	v_add_f32 v148, v124, v126
	v_add_f32 v149, v125, v127
	v_sub_f32 v124, v124, v126
	v_sub_f32 v125, v125, v127
	v_fmac_f32 v148, v124, v183
	v_fmac_f32 v149, v125, v183
	v_mul_f32 v150, v125, v179
	v_mul_f32 v151, -v124, v179
	ds_write_b128 v189, v[80:83] offset:0
	ds_write_b128 v189, v[84:87] offset:1024
	ds_write_b128 v189, v[88:91] offset:2048
	ds_write_b128 v189, v[92:95] offset:3072
	s_waitcnt lgkmcnt(0)
	s_barrier
	s_cmp_eq_u32 s30, 0
	s_cbranch_scc1 L_38
	ds_read_b128 v[96:99], v190 offset:0
	ds_read_b128 v[100:103], v190 offset:1024
	ds_read_b128 v[104:107], v190 offset:2048
	ds_read_b128 v[108:111], v190 offset:3072
	s_branch L_39
L_38:
	ds_read_b32 v96, v200
	ds_read_b32 v100, v200 offset:1024
	ds_read_b32 v97, v201
	ds_read_b32 v101, v201 offset:1024
	ds_read_b32 v98, v202
	ds_read_b32 v102, v202 offset:1024
	ds_read_b32 v99, v203
	ds_read_b32 v103, v203 offset:1024
	ds_read_b32 v104, v204
	ds_read_b32 v108, v204 offset:1024
	ds_read_b32 v105, v205
	ds_read_b32 v109, v205 offset:1024
	ds_read_b32 v106, v206
	ds_read_b32 v110, v206 offset:1024
	ds_read_b32 v107, v207
	ds_read_b32 v111, v207 offset:1024
	s_waitcnt lgkmcnt(0)
	v_xor_b32 v100, 0x80000000, v100
	v_xor_b32 v101, 0x80000000, v101
	v_xor_b32 v102, 0x80000000, v102
	v_xor_b32 v103, 0x80000000, v103
	v_xor_b32 v108, 0x80000000, v108
	v_xor_b32 v109, 0x80000000, v109
	v_xor_b32 v110, 0x80000000, v110
	v_xor_b32 v111, 0x80000000, v111
L_39:
	v_mul_f32 v56, v24, v80
	v_mul_f32 v64, v24, v84
	v_fma_f32 v56, -v25, v84, v56
	v_fmac_f32 v64, v25, v80
	s_lshr_b32 s36, s2, 3
	s_mul_i32 s36, s36, 48
	v_min_u32 v4, 47, v0
	v_add_u32 v4, s36, v4
	v_lshrrev_b32 v5, 2, v4
	v_mul_u32_u24 v6, 0x15556, v5
	v_lshrrev_b32 v6, 23, v6
	v_mul_u32_u24 v6, 256, v6
	v_add_u32 v5, v6, v5
	v_add_u32 v5, 32, v5
	v_and_b32 v4, 3, v4
	v_min_u32 v5, 0x55f, v5
	v_lshlrev_b32 v5, 12, v5
	v_lshl_add_u32 v4, v4, 7, v5
	s_and_b32 s36, s2, 7
	s_lshl_b32 s36, s36, 9
	v_add_u32 v4, s36, v4
	global_load_dword v23, v4, s[16:17]
	v_mul_f32 v57, v28, v81
	v_mul_f32 v65, v28, v85
	v_fma_f32 v57, -v29, v85, v57
	v_fmac_f32 v65, v29, v81
	v_mul_f32 v58, v32, v82
	v_mul_f32 v66, v32, v86
	v_fma_f32 v58, -v33, v86, v58
	v_fmac_f32 v66, v33, v82
	v_mul_f32 v59, v36, v83
	v_mul_f32 v67, v36, v87
	v_fma_f32 v59, -v37, v87, v59
	v_fmac_f32 v67, v37, v83
	v_mul_f32 v60, v136, v88
	v_mul_f32 v68, v136, v92
	v_fma_f32 v60, -v137, v92, v60
	v_fmac_f32 v68, v137, v88
	v_mul_f32 v61, v140, v89
	v_mul_f32 v69, v140, v93
	v_fma_f32 v61, -v141, v93, v61
	v_fmac_f32 v69, v141, v89
	v_mul_f32 v62, v144, v90
	v_mul_f32 v70, v144, v94
	v_fma_f32 v62, -v145, v94, v62
	v_fmac_f32 v70, v145, v90
	v_mul_f32 v63, v148, v91
	v_mul_f32 v71, v148, v95
	v_fma_f32 v63, -v149, v95, v63
	v_fmac_f32 v71, v149, v91
	s_waitcnt lgkmcnt(0)
	v_fmac_f32 v56, v26, v96
	v_fmac_f32 v64, v26, v100
	v_fma_f32 v56, -v27, v100, v56
	v_fmac_f32 v64, v27, v96
	v_fmac_f32 v57, v30, v97
	v_fmac_f32 v65, v30, v101
	v_fma_f32 v57, -v31, v101, v57
	v_fmac_f32 v65, v31, v97
	v_fmac_f32 v58, v34, v98
	v_fmac_f32 v66, v34, v102
	v_fma_f32 v58, -v35, v102, v58
	v_fmac_f32 v66, v35, v98
	s_lshr_b32 s36, s2, 3
	s_lshl_b32 s36, s36, 5
	v_bfe_u32 v4, v0, 2, 5
	v_add_u32 v4, s36, v4
	v_lshrrev_b32 v5, 8, v4
	v_and_b32 v4, 255, v4
	v_lshl_add_u32 v4, v5, 9, v4
	v_add_u32 v4, 256, v4
	v_mul_u32_u24 v4, 2752, v4
	v_and_b32 v5, 3, v0
	v_lshlrev_b32 v5, 7, v5
	v_min_u32 v5, 380, v5
	s_and_b32 s36, s2, 7
	s_mul_i32 s36, s36, 384
	v_add_u32 v5, s36, v5
	v_min_u32 v5, 2748, v5
	v_add_u32 v4, v4, v5
	s_cmp_lt_u32 s3, 2
	s_cselect_b32 s36, -1, 0
	v_and_b32 v4, s36, v4
	global_load_dword v23, v4, s[12:13]
	v_fmac_f32 v59, v38, v99
	v_fmac_f32 v67, v38, v103
	v_fma_f32 v59, -v39, v103, v59
	v_fmac_f32 v67, v39, v99
	v_fmac_f32 v60, v138, v104
	v_fmac_f32 v68, v138, v108
	v_fma_f32 v60, -v139, v108, v60
	v_fmac_f32 v68, v139, v104
	v_fmac_f32 v61, v142, v105
	v_fmac_f32 v69, v142, v109
	v_fma_f32 v61, -v143, v109, v61
	v_fmac_f32 v69, v143, v105
	v_fmac_f32 v62, v146, v106
	v_fmac_f32 v70, v146, v110
	v_fma_f32 v62, -v147, v110, v62
	v_fmac_f32 v70, v147, v106
	v_fmac_f32 v63, v150, v107
	v_fmac_f32 v71, v150, v111
	v_fma_f32 v63, -v151, v111, v63
	v_fmac_f32 v71, v151, v107
	v_cvt_pk_bf16_f32 v112, v56, -v64
	v_cvt_pk_bf16_f32 v113, v57, -v65
	v_cvt_pk_bf16_f32 v114, v58, -v66
	v_cvt_pk_bf16_f32 v115, v59, -v67
	v_cvt_pk_bf16_f32 v116, v60, -v68
	v_cvt_pk_bf16_f32 v117, v61, -v69
	v_cvt_pk_bf16_f32 v118, v62, -v70
	v_cvt_pk_bf16_f32 v119, v63, -v71
	v_mfma_f32_16x16x32_bf16 v[80:83], v[112:115], v[224:227], 0
	s_nop 0
	v_mfma_f32_16x16x32_bf16 v[80:83], v[116:119], v[232:235], v[80:83]
	v_mfma_f32_16x16x32_bf16 v[84:87], v[112:115], v[228:231], 0
	v_mfma_f32_16x16x32_bf16 v[84:87], v[116:119], v[236:239], v[84:87]
	v_mfma_f32_16x16x32_bf16 v[88:91], v[112:115], v[240:243], 0
	v_mfma_f32_16x16x32_bf16 v[88:91], v[116:119], v[248:251], v[88:91]
	v_mfma_f32_16x16x32_bf16 v[92:95], v[112:115], v[244:247], 0
	v_mfma_f32_16x16x32_bf16 v[92:95], v[116:119], v[252:255], v[92:95]
	s_nop 5
	v_mul_f32 v124, v88, v160
	s_nop 0
	v_mul_f32 v128, v92, v160
	v_mul_f32 v125, v89, v161
	v_mul_f32 v129, v93, v161
	v_mul_f32 v126, v90, v162
	v_mul_f32 v130, v94, v162
	v_mul_f32 v127, v91, v163
	v_mul_f32 v131, v95, v163
	v_fmac_f32 v124, v92, v164
	v_fma_f32 v128, -v88, v164, v128
	v_fmac_f32 v125, v93, v165
	v_fma_f32 v129, -v89, v165, v129
	v_fmac_f32 v126, v94, v166
	v_fma_f32 v130, -v90, v166, v130
	v_fmac_f32 v127, v95, v167
	v_fma_f32 v131, -v91, v167, v131
	v_cvt_pk_bf16_f32 v76, v124, v128
	v_cvt_pk_bf16_f32 v77, v125, v129
	v_cvt_pk_bf16_f32 v78, v126, v130
	v_cvt_pk_bf16_f32 v79, v127, v131
	ds_write_b128 v191, v[76:79]
	v_mul_f32 v124, v80, v152
	v_mul_f32 v128, v84, v152
	v_mul_f32 v125, v81, v153
	v_mul_f32 v129, v85, v153
	v_mul_f32 v126, v82, v154
	v_mul_f32 v130, v86, v154
	v_mul_f32 v127, v83, v155
	v_mul_f32 v131, v87, v155
	v_fmac_f32 v124, v84, v156
	v_fma_f32 v128, -v80, v156, v128
	v_fmac_f32 v125, v85, v157
	v_fma_f32 v129, -v81, v157, v129
	v_fmac_f32 v126, v86, v158
	v_fma_f32 v130, -v82, v158, v130
	v_fmac_f32 v127, v87, v159
	v_fma_f32 v131, -v83, v159, v131
	v_cvt_pk_bf16_f32 v72, v124, v128
	v_cvt_pk_bf16_f32 v73, v125, v129
	v_cvt_pk_bf16_f32 v74, v126, v130
	v_cvt_pk_bf16_f32 v75, v127, v131
	s_waitcnt lgkmcnt(0)
	s_barrier
	ds_read_b128 v[120:123], v192
	v_mfma_f32_16x16x32_bf16 v[96:99], v[72:75], v[224:227], 0
	v_mfma_f32_16x16x32_bf16 v[100:103], v[72:75], v[228:231], 0
	v_mfma_f32_16x16x32_bf16 v[104:107], v[72:75], v[240:243], 0
	v_mfma_f32_16x16x32_bf16 v[108:111], v[72:75], v[244:247], 0
	s_waitcnt lgkmcnt(0)
	v_mfma_f32_16x16x32_bf16 v[96:99], v[120:123], v[232:235], v[96:99]
	v_mfma_f32_16x16x32_bf16 v[100:103], v[120:123], v[236:239], v[100:103]
	v_mfma_f32_16x16x32_bf16 v[104:107], v[120:123], v[248:251], v[104:107]
	v_mfma_f32_16x16x32_bf16 v[108:111], v[120:123], v[252:255], v[108:111]
	s_nop 5
	v_cvt_pk_bf16_f32 v24, v96, v100
	v_cvt_pk_bf16_f32 v25, v97, v101
	v_cvt_pk_bf16_f32 v26, v98, v102
	v_cvt_pk_bf16_f32 v27, v99, v103
	v_xor_b32 v24, s57, v24
	v_xor_b32 v25, s57, v25
	v_xor_b32 v26, s57, v26
	v_xor_b32 v27, s57, v27
	global_store_dwordx4 v193, v[24:27], s[52:53] sc1
	v_cvt_pk_bf16_f32 v28, v104, v108
	v_cvt_pk_bf16_f32 v29, v105, v109
	v_cvt_pk_bf16_f32 v30, v106, v110
	v_cvt_pk_bf16_f32 v31, v107, v111
	v_xor_b32 v28, s57, v28
	v_xor_b32 v29, s57, v29
	v_xor_b32 v30, s57, v30
	v_xor_b32 v31, s57, v31
	global_store_dwordx4 v193, v[28:31], s[54:55] sc1
	s_bitcmp1_b32 0x100, s98
	s_cbranch_scc0 Ltr_40
	s_mov_b32 s63, 2
	s_waitcnt vmcnt(4)
	s_branch LT_23
Ltr_40:
	s_bitcmp1_b32 0x1eff, s98
	s_cbranch_scc0 Lj_41
	s_mov_b32 m0, s99
	s_nop 0
	global_load_lds_dwordx4 v16, s[64:65]
	s_add_u32 m0, m0, 0x400
	s_nop 0
	global_load_lds_dwordx4 v17, s[64:65]
	s_add_u32 m0, m0, 0x400
	s_nop 0
	global_load_lds_dwordx4 v18, s[64:65]
	s_bitcmp1_b32 0x3fc0ff, s98
	s_cbranch_scc1 Lj3_42
	s_add_u32 m0, m0, 0x400
	s_nop 0
	global_load_lds_dwordx4 v19, s[64:65]
Lj3_42:
	s_add_u32 s64, s64, s101
	s_addc_u32 s65, s65, 0
	s_add_u32 s99, s99, s0
	s_add_u32 s98, s98, 1
Lj_41:
	s_bitcmp1_b32 0x1eff, s98
	s_cbranch_scc0 Lj_43
	s_mov_b32 m0, s99
	s_nop 0
	global_load_lds_dwordx4 v16, s[64:65]
	s_add_u32 m0, m0, 0x400
	s_nop 0
	global_load_lds_dwordx4 v17, s[64:65]
	s_add_u32 m0, m0, 0x400
	s_nop 0
	global_load_lds_dwordx4 v18, s[64:65]
	s_bitcmp1_b32 0x3fc0ff, s98
	s_cbranch_scc1 Lj3_44
	s_add_u32 m0, m0, 0x400
	s_nop 0
	global_load_lds_dwordx4 v19, s[64:65]
Lj3_44:
	s_add_u32 s64, s64, s101
	s_addc_u32 s65, s65, 0
	s_add_u32 s99, s99, s0
	s_add_u32 s98, s98, 1
Lj_43:
	s_bitcmp1_b32 0x1eff, s98
	s_cbranch_scc0 Lj_45
	s_mov_b32 m0, s99
	s_nop 0
	global_load_lds_dwordx4 v16, s[64:65]
	s_add_u32 m0, m0, 0x400
	s_nop 0
	global_load_lds_dwordx4 v17, s[64:65]
	s_add_u32 m0, m0, 0x400
	s_nop 0
	global_load_lds_dwordx4 v18, s[64:65]
	s_bitcmp1_b32 0x3fc0ff, s98
	s_cbranch_scc1 Lj3_46
	s_add_u32 m0, m0, 0x400
	s_nop 0
	global_load_lds_dwordx4 v19, s[64:65]
Lj3_46:
	s_add_u32 s64, s64, s101
	s_addc_u32 s65, s65, 0
	s_add_u32 s99, s99, s0
	s_add_u32 s98, s98, 1
Lj_45:
	s_bitcmp1_b32 0x1eff, s98
	s_cbranch_scc0 Lj_47
	s_mov_b32 m0, s99
	s_nop 0
	global_load_lds_dwordx4 v16, s[64:65]
	s_add_u32 m0, m0, 0x400
	s_nop 0
	global_load_lds_dwordx4 v17, s[64:65]
	s_add_u32 m0, m0, 0x400
	s_nop 0
	global_load_lds_dwordx4 v18, s[64:65]
	s_bitcmp1_b32 0x3fc0ff, s98
	s_cbranch_scc1 Lj3_48
	s_add_u32 m0, m0, 0x400
	s_nop 0
	global_load_lds_dwordx4 v19, s[64:65]
Lj3_48:
	s_add_u32 s64, s64, s101
	s_addc_u32 s65, s65, 0
	s_add_u32 s99, s99, s0
	s_add_u32 s98, s98, 1
Lj_47:
	s_cmp_eq_u32 s32, 0
	s_cbranch_scc1 L_49
	v_swap_b32 v224, v248
	v_swap_b32 v225, v249
	v_swap_b32 v226, v250
	v_swap_b32 v227, v251
	v_swap_b32 v228, v252
	v_swap_b32 v229, v253
	v_swap_b32 v230, v254
	v_swap_b32 v231, v255
	v_swap_b32 v232, v240
	v_swap_b32 v233, v241
	v_swap_b32 v234, v242
	v_swap_b32 v235, v243
	v_swap_b32 v236, v244
	v_swap_b32 v237, v245
	v_swap_b32 v238, v246
	v_swap_b32 v239, v247
L_49:
	s_barrier
	s_and_b32 s30, s2, 7
	s_lshr_b32 s31, s2, 3
	s_lshr_b32 s32, s31, 2
	s_lshl_b32 s32, s32, 3
	s_add_u32 s30, s30, s32
	s_and_b32 s32, s30, 1
	s_bfe_u32 s33, s30, 0x10001
	s_bfe_u32 s34, s30, 0x20002
	s_lshr_b32 s35, s30, 4
	s_lshl_b32 s35, s35, 2
	s_and_b32 s31, s31, 3
	s_add_u32 s35, s35, s31
	s_lshl_b32 s36, s35, 1
	s_add_u32 s36, s36, s33
	s_lshl_b32 s37, s32, 12
	s_lshl_b32 s38, s33, 11
	s_add_u32 s37, s37, s38
	s_lshl_b32 s38, s34, 9
	s_add_u32 s37, s37, s38
	s_lshl_b32 s38, s35, 5
	s_add_u32 s37, s37, s38
	s_lshl_b32 s38, s36, 3
	s_lshl_b32 s39, s34, 1
	s_add_u32 s38, s38, s39
	s_add_u32 s38, s38, s32
	s_lshl_b32 s39, s36, 5
	s_lshl_b32 s40, s34, 3
	s_add_u32 s39, s39, s40
	s_lshl_b32 s40, s3, 1
	s_add_u32 s39, s39, s40
	s_add_u32 s39, s39, s32
	s_lshl_b32 s39, s39, 11
	v_lshlrev_b32 v185, 6, v2
	v_lshl_add_u32 v185, v3, 4, v185
	s_add_u32 s42, s24, s37
	s_addc_u32 s43, s25, 0
	s_add_u32 s42, s42, 5242880
	s_addc_u32 s43, s43, 0
	s_add_u32 s44, s4, s39
	s_addc_u32 s45, s5, 0
	s_add_u32 s46, s24, s39
	s_addc_u32 s47, s25, 0
	s_add_u32 s46, s46, 7340032
	s_addc_u32 s47, s47, 0
	s_lshl_b32 s38, s38, 13
	s_add_u32 s48, s24, s38
	s_addc_u32 s49, s25, 0
	s_add_u32 s48, s48, 9437184
	s_addc_u32 s49, s49, 0
	global_load_dwordx4 v[32:35], v185, s[44:45]
	global_load_dwordx4 v[36:39], v185, s[44:45] offset:1024
	v_lshrrev_b32 v4, 1, v1
	s_lshl_b32 s40, s3, 6
	v_add_u32 v4, s40, v4
	v_and_b32 v5, 1, v1
	v_lshlrev_b32 v6, 13, v4
	v_lshl_add_u32 v184, v5, 4, v6
	v_add_u32 v6, 0, v4
	v_sub_u32 v7, 0x200, v6
	v_cmp_eq_u32 vcc, 0, v6
	v_mov_b32 v8, 0x100
	s_nop 0
	v_cndmask_b32 v7, v7, v8, vcc
	v_cmp_eq_u32 vcc, 1, v5
	s_nop 1
	v_cndmask_b32 v7, v6, v7, vcc
	v_lshrrev_b32 v8, 7, v7
	v_lshl_add_u32 v7, v8, 4, v7
	v_lshlrev_b32 v7, 2, v7
	v_add_u32 v186, 126976, v7
	v_add_u32 v6, 32, v4
	v_sub_u32 v7, 0x200, v6
	v_cmp_eq_u32 vcc, 0, v6
	v_mov_b32 v8, 0x100
	s_nop 0
	v_cndmask_b32 v7, v7, v8, vcc
	v_cmp_eq_u32 vcc, 1, v5
	s_nop 1
	v_cndmask_b32 v7, v6, v7, vcc
	v_lshrrev_b32 v8, 7, v7
	v_lshl_add_u32 v7, v8, 4, v7
	v_lshlrev_b32 v7, 2, v7
	v_add_u32 v187, 126976, v7
	s_add_u32 s50, s42, 262144
	s_addc_u32 s51, s43, 0
	s_mul_i32 s40, s3, 4384
	s_add_u32 s40, s40, 126976
	v_mul_u32_u24 v188, 144, v3
	v_add_u32 v188, v188, v2
	v_lshlrev_b32 v188, 2, v188
	v_add_u32 v188, s40, v188
	s_lshl_b32 s40, s3, 11
	s_add_u32 s40, s40, 147456
	v_lshlrev_b32 v189, 1, v185
	v_add_u32 v189, s40, v189
	v_lshlrev_b32 v190, 2, v0
	v_add_u32 v190, 147456, v190
	s_mov_b32 s52, 0x35800000
	s_mov_b32 s53, 0xb5800000
	v_lshlrev_b32 v6, 2, v3
	v_cvt_f32_u32 v6, v6
	v_lshlrev_b32 v5, 1, v2
	v_cvt_f32_u32 v5, v5
	v_mul_f32 v5, 0x3b000000, v5
	v_mul_f32 v7, v6, v5
	v_cos_f32 v136, v7
	v_sin_f32 v140, v7
	v_fmamk_f32 v141, v5, 0x3f800000, v7
	v_fmamk_f32 v142, v5, 0x40000000, v7
	v_fmamk_f32 v143, v5, 0x40400000, v7
	v_cos_f32 v137, v141
	v_sin_f32 v141, v141
	v_cos_f32 v138, v142
	v_sin_f32 v142, v142
	v_cos_f32 v139, v143
	v_sin_f32 v143, v143
	v_lshlrev_b32 v5, 1, v2
	v_add_u32 v5, 1, v5
	v_cvt_f32_u32 v5, v5
	v_mul_f32 v5, 0x3b000000, v5
	v_mul_f32 v7, v6, v5
	v_cos_f32 v144, v7
	v_sin_f32 v148, v7
	v_fmamk_f32 v149, v5, 0x3f800000, v7
	v_fmamk_f32 v150, v5, 0x40000000, v7
	v_fmamk_f32 v151, v5, 0x40400000, v7
	v_cos_f32 v145, v149
	v_sin_f32 v149, v149
	v_cos_f32 v146, v150
	v_sin_f32 v150, v150
	v_cos_f32 v147, v151
	v_sin_f32 v151, v151
	s_lshl_b32 s58, s2, 13
	s_add_u32 s58, s58, 11534336
	global_load_dwordx4 v[24:27], v184, s[42:43] sc1
	global_load_dwordx4 v[28:31], v184, s[50:51] sc1
	s_bitcmp1_b32 0x402100, s98
	s_cbranch_scc0 Ltr_50
	s_mov_b32 s63, 0
	s_waitcnt vmcnt(4)
	s_cmp_eq_u32 s98, 8
	s_cbranch_scc1 LT_51
	s_cmp_eq_u32 s98, 13
	s_cbranch_scc1 LT_52
	s_branch LT_53
Ltr_50:
	s_waitcnt vmcnt(2)
	v_lshlrev_b32 v88, 16, v32
	v_and_b32 v89, 0xffff0000, v32
	v_lshlrev_b32 v90, 16, v33
	v_and_b32 v91, 0xffff0000, v33
	v_lshlrev_b32 v92, 16, v34
	v_and_b32 v93, 0xffff0000, v34
	v_lshlrev_b32 v94, 16, v35
	v_and_b32 v95, 0xffff0000, v35
	v_lshlrev_b32 v96, 16, v36
	v_and_b32 v97, 0xffff0000, v36
	v_lshlrev_b32 v98, 16, v37
	v_and_b32 v99, 0xffff0000, v37
	v_lshlrev_b32 v100, 16, v38
	v_and_b32 v101, 0xffff0000, v38
	v_lshlrev_b32 v102, 16, v39
	v_and_b32 v103, 0xffff0000, v39
	s_mov_b32 s28, 0
	s_waitcnt vmcnt(0)
Lqc_56:
	v_max3_u32 v4, v24, v25, v26
	v_max3_u32 v4, v4, v27, v28
	v_max3_u32 v4, v4, v29, v30
	v_max_u32 v4, v4, v31
	v_cmp_eq_u32 vcc, -1, v4
	s_cbranch_vccz Lqd_55
	s_add_u32 s28, s28, 1
	s_cmp_gt_u32 s28, 20000
	s_cbranch_scc1 Lqd_55
	s_bitcmp1_b32 0x402100, s98
	s_cbranch_scc0 Ltr_57
	s_mov_b32 s63, 1
	s_waitcnt vmcnt(0)
	s_cmp_eq_u32 s98, 8
	s_cbranch_scc1 LT_51
	s_cmp_eq_u32 s98, 13
	s_cbranch_scc1 LT_52
	s_branch LT_53
Ltr_57:
	s_mov_b64 exec, vcc
	global_load_dwordx4 v[24:27], v184, s[42:43] sc1
	global_load_dwordx4 v[28:31], v184, s[50:51] sc1
	s_mov_b64 exec, -1
	s_waitcnt vmcnt(0)
	s_branch Lqc_56
Lqd_55:
	ds_write_b32 v186, v24 offset:0
	ds_write_b32 v186, v25 offset:4384
	ds_write_b32 v186, v26 offset:8768
	ds_write_b32 v186, v27 offset:13152
	ds_write_b32 v187, v28 offset:0
	ds_write_b32 v187, v29 offset:4384
	ds_write_b32 v187, v30 offset:8768
	ds_write_b32 v187, v31 offset:13152
	s_cmp_ge_u32 s2, 172
	s_cbranch_scc1 L_58
	v_lshlrev_b32 v8, 4, v0
	v_add_u32 v8, s58, v8
	v_mov_b32 v4, -1
	v_mov_b32 v5, -1
	v_mov_b32 v6, -1
	v_mov_b32 v7, -1
	global_store_dwordx4 v8, v[4:7], s[24:25] sc1
	v_add_u32 v8, 0x1000, v8
	global_store_dwordx4 v8, v[4:7], s[24:25] sc1
L_58:
	s_waitcnt lgkmcnt(0)
	s_bitcmp1_b32 0x3fdeff, s98
	s_cbranch_scc0 Lj_59
	s_mov_b32 m0, s99
	s_nop 0
	global_load_lds_dwordx4 v16, s[64:65]
	s_add_u32 m0, m0, 0x400
	s_nop 0
	global_load_lds_dwordx4 v17, s[64:65]
	s_add_u32 m0, m0, 0x400
	s_nop 0
	global_load_lds_dwordx4 v18, s[64:65]
	s_bitcmp1_b32 0x3fc0ff, s98
	s_cbranch_scc1 Lj3_60
	s_add_u32 m0, m0, 0x400
	s_nop 0
	global_load_lds_dwordx4 v19, s[64:65]
Lj3_60:
	s_add_u32 s64, s64, s101
	s_addc_u32 s65, s65, 0
	s_add_u32 s99, s99, s0
	s_add_u32 s98, s98, 1
Lj_59:
	s_barrier
	ds_read_b32 v40, v188 offset:0
	ds_read_b32 v41, v188 offset:128
	ds_read_b32 v42, v188 offset:256
	ds_read_b32 v43, v188 offset:384
	ds_read_b32 v44, v188 offset:64
	ds_read_b32 v45, v188 offset:192
	ds_read_b32 v46, v188 offset:320
	ds_read_b32 v47, v188 offset:448
	s_waitcnt lgkmcnt(4)
	v_mfma_f32_16x16x32_bf16 v[48:51], v[40:43], v[224:227], 0
	v_mfma_f32_16x16x32_bf16 v[52:55], v[40:43], v[228:231], 0
	v_mfma_f32_16x16x32_bf16 v[56:59], v[40:43], v[240:243], 0
	v_mfma_f32_16x16x32_bf16 v[60:63], v[40:43], v[244:247], 0
	s_waitcnt lgkmcnt(0)
	v_mfma_f32_16x16x32_bf16 v[48:51], v[44:47], v[232:235], v[48:51]
	v_mfma_f32_16x16x32_bf16 v[52:55], v[44:47], v[236:239], v[52:55]
	v_mfma_f32_16x16x32_bf16 v[56:59], v[44:47], v[248:251], v[56:59]
	v_mfma_f32_16x16x32_bf16 v[60:63], v[44:47], v[252:255], v[60:63]
	s_nop 4
	v_mul_f32 v112, v48, v136
	v_mul_f32 v116, v52, v136
	v_mul_f32 v113, v49, v137
	v_mul_f32 v117, v53, v137
	v_mul_f32 v114, v50, v138
	v_mul_f32 v118, v54, v138
	v_mul_f32 v115, v51, v139
	v_mul_f32 v119, v55, v139
	v_fmac_f32 v112, v52, v140
	v_fma_f32 v116, -v48, v140, v116
	v_fmac_f32 v113, v53, v141
	v_fma_f32 v117, -v49, v141, v117
	v_fmac_f32 v114, v54, v142
	v_fma_f32 v118, -v50, v142, v118
	v_fmac_f32 v115, v55, v143
	v_fma_f32 v119, -v51, v143, v119
	s_bitcmp1_b32 0x3fdeff, s98
	s_cbranch_scc0 Lj_61
	s_mov_b32 m0, s99
	s_nop 0
	global_load_lds_dwordx4 v16, s[64:65]
	s_add_u32 m0, m0, 0x400
	s_nop 0
	global_load_lds_dwordx4 v17, s[64:65]
	s_add_u32 m0, m0, 0x400
	s_nop 0
	global_load_lds_dwordx4 v18, s[64:65]
	s_bitcmp1_b32 0x3fc0ff, s98
	s_cbranch_scc1 Lj3_62
	s_add_u32 m0, m0, 0x400
	s_nop 0
	global_load_lds_dwordx4 v19, s[64:65]
Lj3_62:
	s_add_u32 s64, s64, s101
	s_addc_u32 s65, s65, 0
	s_add_u32 s99, s99, s0
	s_add_u32 s98, s98, 1
Lj_61:
	v_cvt_pk_bf16_f32 v64, v112, v116
	v_cvt_pk_bf16_f32 v65, v113, v117
	v_cvt_pk_bf16_f32 v66, v114, v118
	v_cvt_pk_bf16_f32 v67, v115, v119
	v_mul_f32 v112, v56, v144
	v_mul_f32 v116, v60, v144
	v_mul_f32 v113, v57, v145
	v_mul_f32 v117, v61, v145
	v_mul_f32 v114, v58, v146
	v_mul_f32 v118, v62, v146
	v_mul_f32 v115, v59, v147
	v_mul_f32 v119, v63, v147
	v_fmac_f32 v112, v60, v148
	v_fma_f32 v116, -v56, v148, v116
	v_fmac_f32 v113, v61, v149
	v_fma_f32 v117, -v57, v149, v117
	v_fmac_f32 v114, v62, v150
	v_fma_f32 v118, -v58, v150, v118
	v_fmac_f32 v115, v63, v151
	v_fma_f32 v119, -v59, v151, v119
	v_cvt_pk_bf16_f32 v68, v112, v116
	v_cvt_pk_bf16_f32 v69, v113, v117
	v_cvt_pk_bf16_f32 v70, v114, v118
	v_cvt_pk_bf16_f32 v71, v115, v119
	v_mfma_f32_16x16x32_bf16 v[72:75], v[64:67], v[216:219], 0
	v_mfma_f32_16x16x32_bf16 v[76:79], v[64:67], v[220:223], 0
	v_mfma_f32_16x16x32_bf16 v[80:83], v[68:71], v[216:219], 0
	v_mfma_f32_16x16x32_bf16 v[84:87], v[68:71], v[220:223], 0
	s_nop 6
	v_cvt_pk_bf16_f32 v112, v72, v80
	v_cvt_pk_bf16_f32 v113, v73, v81
	v_cvt_pk_bf16_f32 v114, v74, v82
	v_cvt_pk_bf16_f32 v115, v75, v83
	v_lshlrev_b32 v116, 16, v112
	v_and_b32 v117, 0xffff0000, v112
	v_lshlrev_b32 v118, 16, v113
	v_and_b32 v119, 0xffff0000, v113
	v_lshlrev_b32 v120, 16, v114
	v_and_b32 v121, 0xffff0000, v114
	v_lshlrev_b32 v122, 16, v115
	v_and_b32 v123, 0xffff0000, v115
	v_fma_f32 v88, v116, s52, v88
	v_fma_f32 v89, v117, s52, v89
	v_fma_f32 v90, v118, s52, v90
	v_fma_f32 v91, v119, s52, v91
	v_fma_f32 v92, v120, s52, v92
	v_fma_f32 v93, v121, s52, v93
	v_fma_f32 v94, v122, s52, v94
	v_fma_f32 v95, v123, s52, v95
	v_cvt_pk_bf16_f32 v104, v88, v89
	v_cvt_pk_bf16_f32 v105, v90, v91
	v_cvt_pk_bf16_f32 v106, v92, v93
	v_cvt_pk_bf16_f32 v107, v94, v95
	v_cvt_pk_bf16_f32 v112, v76, v84
	v_cvt_pk_bf16_f32 v113, v77, v85
	v_cvt_pk_bf16_f32 v114, v78, v86
	v_cvt_pk_bf16_f32 v115, v79, v87
	v_lshlrev_b32 v116, 16, v112
	v_and_b32 v117, 0xffff0000, v112
	v_lshlrev_b32 v118, 16, v113
	v_and_b32 v119, 0xffff0000, v113
	v_lshlrev_b32 v120, 16, v114
	v_and_b32 v121, 0xffff0000, v114
	v_lshlrev_b32 v122, 16, v115
	v_and_b32 v123, 0xffff0000, v115
	s_bitcmp1_b32 0x3fdeff, s98
	s_cbranch_scc0 Lj_63
	s_mov_b32 m0, s99
	s_nop 0
	global_load_lds_dwordx4 v16, s[64:65]
	s_add_u32 m0, m0, 0x400
	s_nop 0
	global_load_lds_dwordx4 v17, s[64:65]
	s_add_u32 m0, m0, 0x400
	s_nop 0
	global_load_lds_dwordx4 v18, s[64:65]
	s_bitcmp1_b32 0x3fc0ff, s98
	s_cbranch_scc1 Lj3_64
	s_add_u32 m0, m0, 0x400
	s_nop 0
	global_load_lds_dwordx4 v19, s[64:65]
Lj3_64:
	s_add_u32 s64, s64, s101
	s_addc_u32 s65, s65, 0
	s_add_u32 s99, s99, s0
	s_add_u32 s98, s98, 1
Lj_63:
	v_fma_f32 v96, v116, s53, v96
	v_fma_f32 v97, v117, s53, v97
	v_fma_f32 v98, v118, s53, v98
	v_fma_f32 v99, v119, s53, v99
	v_fma_f32 v100, v120, s53, v100
	v_fma_f32 v101, v121, s53, v101
	v_fma_f32 v102, v122, s53, v102
	v_fma_f32 v103, v123, s53, v103
	v_cvt_pk_bf16_f32 v108, v96, v97
	v_cvt_pk_bf16_f32 v109, v98, v99
	v_cvt_pk_bf16_f32 v110, v100, v101
	v_cvt_pk_bf16_f32 v111, v102, v103
	global_store_dwordx4 v185, v[104:107], s[46:47] sc1
	global_store_dwordx4 v185, v[108:111], s[46:47] offset:1024 sc1
	v_dot2_f32_bf16 v112, v104, v22, 0
	v_dot2_f32_bf16 v113, v104, v104, 0
	v_dot2_f32_bf16 v114, v108, v22, 0
	v_dot2_f32_bf16 v115, v108, v108, 0
	v_dot2_f32_bf16 v112, v105, v22, v112
	v_dot2_f32_bf16 v113, v105, v105, v113
	v_dot2_f32_bf16 v114, v109, v22, v114
	v_dot2_f32_bf16 v115, v109, v109, v115
	v_dot2_f32_bf16 v112, v106, v22, v112
	v_dot2_f32_bf16 v113, v106, v106, v113
	v_dot2_f32_bf16 v114, v110, v22, v114
	v_dot2_f32_bf16 v115, v110, v110, v115
	v_dot2_f32_bf16 v112, v107, v22, v112
	v_dot2_f32_bf16 v113, v107, v107, v113
	v_dot2_f32_bf16 v114, v111, v22, v114
	v_dot2_f32_bf16 v115, v111, v111, v115
	v_lshlrev_b32 v88, 16, v104
	v_and_b32 v89, 0xffff0000, v104
	v_lshlrev_b32 v90, 16, v105
	v_and_b32 v91, 0xffff0000, v105
	v_lshlrev_b32 v92, 16, v106
	v_and_b32 v93, 0xffff0000, v106
	v_lshlrev_b32 v94, 16, v107
	v_and_b32 v95, 0xffff0000, v107
	v_lshlrev_b32 v96, 16, v108
	v_and_b32 v97, 0xffff0000, v108
	v_lshlrev_b32 v98, 16, v109
	v_and_b32 v99, 0xffff0000, v109
	v_lshlrev_b32 v100, 16, v110
	v_and_b32 v101, 0xffff0000, v110
	v_lshlrev_b32 v102, 16, v111
	v_and_b32 v103, 0xffff0000, v111
	v_permlane32_swap_b32 v112, v114
	v_permlane32_swap_b32 v113, v115
	v_add_f32 v116, v112, v114
	v_add_f32 v117, v113, v115
	s_nop 1
	v_permlane16_swap_b32 v116, v117
	v_add_f32 v116, v116, v117
	s_nop 1
	v_add_f32_dpp v116, v116, v116 quad_perm:[1,0,3,2] row_mask:0xf bank_mask:0xf
	s_nop 1
	v_add_f32_dpp v116, v116, v116 quad_perm:[2,3,0,1] row_mask:0xf bank_mask:0xf
	s_nop 1
	v_add_f32_dpp v116, v116, v116 row_half_mirror row_mask:0xf bank_mask:0xf
	s_nop 1
	v_add_f32_dpp v116, v116, v116 row_mirror row_mask:0xf bank_mask:0xf
	v_mov_b32 v117, v116
	s_nop 1
	v_permlane16_swap_b32 v116, v117
	s_bitcmp1_b32 0x3fdeff, s98
	s_cbranch_scc0 Lj_65
	s_mov_b32 m0, s99
	s_nop 0
	global_load_lds_dwordx4 v16, s[64:65]
	s_add_u32 m0, m0, 0x400
	s_nop 0
	global_load_lds_dwordx4 v17, s[64:65]
	s_add_u32 m0, m0, 0x400
	s_nop 0
	global_load_lds_dwordx4 v18, s[64:65]
	s_bitcmp1_b32 0x3fc0ff, s98
	s_cbranch_scc1 Lj3_66
	s_add_u32 m0, m0, 0x400
	s_nop 0
	global_load_lds_dwordx4 v19, s[64:65]
Lj3_66:
	s_add_u32 s64, s64, s101
	s_addc_u32 s65, s65, 0
	s_add_u32 s99, s99, s0
	s_add_u32 s98, s98, 1
Lj_65:
	v_mul_f32 v116, 0x3b000000, v116
	v_mul_f32 v117, 0x3b000000, v117
	v_fma_f32 v117, -v116, v116, v117
	v_max_f32 v117, 0, v117
	v_cvt_pk_bf16_f32 v116, v116, v117
	v_and_b32 v117, 0xffff0000, v116
	v_lshlrev_b32 v116, 16, v116
	v_add_f32 v117, 0x3727c5ac, v117
	v_readlane_b32 s54, v116, 0
	v_readlane_b32 s55, v116, 32
	v_cvt_pk_bf16_f32 v117, v117, v117
	v_lshlrev_b32 v117, 16, v117
	v_sqrt_f32 v117, v117
	s_nop 0
	v_cvt_pk_bf16_f32 v117, v117, v117
	v_lshlrev_b32 v117, 16, v117
	v_rcp_f32 v117, v117
	s_nop 0
	v_readlane_b32 s56, v117, 0
	v_readlane_b32 s57, v117, 32
	v_subrev_f32 v88, s54, v88
	v_subrev_f32 v89, s54, v89
	v_subrev_f32 v90, s54, v90
	v_subrev_f32 v91, s54, v91
	v_subrev_f32 v92, s54, v92
	v_subrev_f32 v93, s54, v93
	v_subrev_f32 v94, s54, v94
	v_subrev_f32 v95, s54, v95
	v_cvt_pk_bf16_f32 v120, v88, v89
	v_cvt_pk_bf16_f32 v121, v90, v91
	v_cvt_pk_bf16_f32 v122, v92, v93
	v_cvt_pk_bf16_f32 v123, v94, v95
	v_lshlrev_b32 v88, 16, v120
	v_and_b32 v89, 0xffff0000, v120
	v_lshlrev_b32 v90, 16, v121
	v_and_b32 v91, 0xffff0000, v121
	v_lshlrev_b32 v92, 16, v122
	v_and_b32 v93, 0xffff0000, v122
	v_lshlrev_b32 v94, 16, v123
	v_and_b32 v95, 0xffff0000, v123
	v_mul_f32 v88, s56, v88
	v_mul_f32 v89, s56, v89
	v_mul_f32 v90, s56, v90
	v_mul_f32 v91, s56, v91
	v_mul_f32 v92, s56, v92
	v_mul_f32 v93, s56, v93
	v_mul_f32 v94, s56, v94
	v_mul_f32 v95, s56, v95
	v_subrev_f32 v96, s55, v96
	v_subrev_f32 v97, s55, v97
	v_subrev_f32 v98, s55, v98
	v_subrev_f32 v99, s55, v99
	v_subrev_f32 v100, s55, v100
	v_subrev_f32 v101, s55, v101
	v_subrev_f32 v102, s55, v102
	v_subrev_f32 v103, s55, v103
	s_bitcmp1_b32 0x3fdeff, s98
	s_cbranch_scc0 Lj_67
	s_mov_b32 m0, s99
	s_nop 0
	global_load_lds_dwordx4 v16, s[64:65]
	s_add_u32 m0, m0, 0x400
	s_nop 0
	global_load_lds_dwordx4 v17, s[64:65]
	s_add_u32 m0, m0, 0x400
	s_nop 0
	global_load_lds_dwordx4 v18, s[64:65]
	s_bitcmp1_b32 0x3fc0ff, s98
	s_cbranch_scc1 Lj3_68
	s_add_u32 m0, m0, 0x400
	s_nop 0
	global_load_lds_dwordx4 v19, s[64:65]
Lj3_68:
	s_add_u32 s64, s64, s101
	s_addc_u32 s65, s65, 0
	s_add_u32 s99, s99, s0
	s_add_u32 s98, s98, 1
Lj_67:
	v_cvt_pk_bf16_f32 v120, v96, v97
	v_cvt_pk_bf16_f32 v121, v98, v99
	v_cvt_pk_bf16_f32 v122, v100, v101
	v_cvt_pk_bf16_f32 v123, v102, v103
	v_lshlrev_b32 v96, 16, v120
	v_and_b32 v97, 0xffff0000, v120
	v_lshlrev_b32 v98, 16, v121
	v_and_b32 v99, 0xffff0000, v121
	v_lshlrev_b32 v100, 16, v122
	v_and_b32 v101, 0xffff0000, v122
	v_lshlrev_b32 v102, 16, v123
	v_and_b32 v103, 0xffff0000, v123
	v_mul_f32 v96, s57, v96
	v_mul_f32 v97, s57, v97
	v_mul_f32 v98, s57, v98
	v_mul_f32 v99, s57, v99
	v_mul_f32 v100, s57, v100
	v_mul_f32 v101, s57, v101
	v_mul_f32 v102, s57, v102
	v_mul_f32 v103, s57, v103
	s_bitcmp1_b32 0x2100, s98
	s_cbranch_scc0 Ltr_69
	s_mov_b32 s63, 2
	s_waitcnt vmcnt(0)
	s_cmp_eq_u32 s98, 8
	s_cbranch_scc1 LT_51
	s_branch LT_52
Ltr_69:
	v_cvt_pk_bf16_f32 v48, v88, v89
	v_cvt_pk_bf16_f32 v52, v96, v97
	v_cvt_pk_bf16_f32 v49, v90, v91
	v_cvt_pk_bf16_f32 v53, v98, v99
	v_cvt_pk_bf16_f32 v50, v92, v93
	v_cvt_pk_bf16_f32 v54, v100, v101
	v_cvt_pk_bf16_f32 v51, v94, v95
	v_cvt_pk_bf16_f32 v55, v102, v103
	v_dot2_f32_bf16 v112, v48, v22, 0
	v_dot2_f32_bf16 v113, v48, v48, 0
	v_dot2_f32_bf16 v114, v52, v22, 0
	v_dot2_f32_bf16 v115, v52, v52, 0
	v_dot2_f32_bf16 v112, v49, v22, v112
	v_dot2_f32_bf16 v113, v49, v49, v113
	v_dot2_f32_bf16 v114, v53, v22, v114
	v_dot2_f32_bf16 v115, v53, v53, v115
	v_dot2_f32_bf16 v112, v50, v22, v112
	v_dot2_f32_bf16 v113, v50, v50, v113
	v_dot2_f32_bf16 v114, v54, v22, v114
	v_dot2_f32_bf16 v115, v54, v54, v115
	v_dot2_f32_bf16 v112, v51, v22, v112
	v_dot2_f32_bf16 v113, v51, v51, v113
	v_dot2_f32_bf16 v114, v55, v22, v114
	v_dot2_f32_bf16 v115, v55, v55, v115
	s_waitcnt lgkmcnt(0)
	v_lshlrev_b32 v88, 16, v48
	v_and_b32 v89, 0xffff0000, v48
	v_lshlrev_b32 v90, 16, v49
	v_and_b32 v91, 0xffff0000, v49
	v_lshlrev_b32 v92, 16, v50
	v_and_b32 v93, 0xffff0000, v50
	v_lshlrev_b32 v94, 16, v51
	v_and_b32 v95, 0xffff0000, v51
	s_bitcmp1_b32 0x3fdeff, s98
	s_cbranch_scc0 Lj_70
	s_mov_b32 m0, s99
	s_nop 0
	global_load_lds_dwordx4 v16, s[64:65]
	s_add_u32 m0, m0, 0x400
	s_nop 0
	global_load_lds_dwordx4 v17, s[64:65]
	s_add_u32 m0, m0, 0x400
	s_nop 0
	global_load_lds_dwordx4 v18, s[64:65]
	s_bitcmp1_b32 0x3fc0ff, s98
	s_cbranch_scc1 Lj3_71
	s_add_u32 m0, m0, 0x400
	s_nop 0
	global_load_lds_dwordx4 v19, s[64:65]
Lj3_71:
	s_add_u32 s64, s64, s101
	s_addc_u32 s65, s65, 0
	s_add_u32 s99, s99, s0
	s_add_u32 s98, s98, 1
Lj_70:
	v_lshlrev_b32 v96, 16, v52
	v_and_b32 v97, 0xffff0000, v52
	v_lshlrev_b32 v98, 16, v53
	v_and_b32 v99, 0xffff0000, v53
	v_lshlrev_b32 v100, 16, v54
	v_and_b32 v101, 0xffff0000, v54
	v_lshlrev_b32 v102, 16, v55
	v_and_b32 v103, 0xffff0000, v55
	v_permlane32_swap_b32 v112, v114
	v_permlane32_swap_b32 v113, v115
	v_add_f32 v116, v112, v114
	v_add_f32 v117, v113, v115
	s_nop 1
	v_permlane16_swap_b32 v116, v117
	v_add_f32 v116, v116, v117
	s_nop 1
	v_add_f32_dpp v116, v116, v116 quad_perm:[1,0,3,2] row_mask:0xf bank_mask:0xf
	s_nop 1
	v_add_f32_dpp v116, v116, v116 quad_perm:[2,3,0,1] row_mask:0xf bank_mask:0xf
	s_nop 1
	v_add_f32_dpp v116, v116, v116 row_half_mirror row_mask:0xf bank_mask:0xf
	s_nop 1
	v_add_f32_dpp v116, v116, v116 row_mirror row_mask:0xf bank_mask:0xf
	v_mov_b32 v117, v116
	s_nop 1
	v_permlane16_swap_b32 v116, v117
	v_mul_f32 v116, 0x3b000000, v116
	v_mul_f32 v117, 0x3b000000, v117
	v_fma_f32 v117, -v116, v116, v117
	v_max_f32 v117, 0, v117
	v_cvt_pk_bf16_f32 v116, v116, v117
	v_and_b32 v117, 0xffff0000, v116
	v_lshlrev_b32 v116, 16, v116
	v_add_f32 v117, 0x3727c5ac, v117
	v_readlane_b32 s54, v116, 0
	v_readlane_b32 s55, v116, 32
	v_cvt_pk_bf16_f32 v117, v117, v117
	v_lshlrev_b32 v117, 16, v117
	v_sqrt_f32 v117, v117
	s_nop 0
	v_cvt_pk_bf16_f32 v117, v117, v117
	v_lshlrev_b32 v117, 16, v117
	v_rcp_f32 v117, v117
	s_nop 0
	v_readlane_b32 s56, v117, 0
	v_readlane_b32 s57, v117, 32
	v_subrev_f32 v88, s54, v88
	v_subrev_f32 v89, s54, v89
	v_subrev_f32 v90, s54, v90
	v_subrev_f32 v91, s54, v91
	v_subrev_f32 v92, s54, v92
	v_subrev_f32 v93, s54, v93
	v_subrev_f32 v94, s54, v94
	v_subrev_f32 v95, s54, v95
	v_cvt_pk_bf16_f32 v120, v88, v89
	v_cvt_pk_bf16_f32 v121, v90, v91
	v_cvt_pk_bf16_f32 v122, v92, v93
	v_cvt_pk_bf16_f32 v123, v94, v95
	v_lshlrev_b32 v88, 16, v120
	v_and_b32 v89, 0xffff0000, v120
	v_lshlrev_b32 v90, 16, v121
	v_and_b32 v91, 0xffff0000, v121
	v_lshlrev_b32 v92, 16, v122
	v_and_b32 v93, 0xffff0000, v122
	v_lshlrev_b32 v94, 16, v123
	v_and_b32 v95, 0xffff0000, v123
	s_bitcmp1_b32 0x3fdeff, s98
	s_cbranch_scc0 Lj_72
	s_mov_b32 m0, s99
	s_nop 0
	global_load_lds_dwordx4 v16, s[64:65]
	s_add_u32 m0, m0, 0x400
	s_nop 0
	global_load_lds_dwordx4 v17, s[64:65]
	s_add_u32 m0, m0, 0x400
	s_nop 0
	global_load_lds_dwordx4 v18, s[64:65]
	s_bitcmp1_b32 0x3fc0ff, s98
	s_cbranch_scc1 Lj3_73
	s_add_u32 m0, m0, 0x400
	s_nop 0
	global_load_lds_dwordx4 v19, s[64:65]
Lj3_73:
	s_add_u32 s64, s64, s101
	s_addc_u32 s65, s65, 0
	s_add_u32 s99, s99, s0
	s_add_u32 s98, s98, 1
Lj_72:
	v_mul_f32 v88, s56, v88
	v_mul_f32 v89, s56, v89
	v_mul_f32 v90, s56, v90
	v_mul_f32 v91, s56, v91
	v_mul_f32 v92, s56, v92
	v_mul_f32 v93, s56, v93
	v_mul_f32 v94, s56, v94
	v_mul_f32 v95, s56, v95
	v_subrev_f32 v96, s55, v96
	v_subrev_f32 v97, s55, v97
	v_subrev_f32 v98, s55, v98
	v_subrev_f32 v99, s55, v99
	v_subrev_f32 v100, s55, v100
	v_subrev_f32 v101, s55, v101
	v_subrev_f32 v102, s55, v102
	v_subrev_f32 v103, s55, v103
	v_cvt_pk_bf16_f32 v120, v96, v97
	v_cvt_pk_bf16_f32 v121, v98, v99
	v_cvt_pk_bf16_f32 v122, v100, v101
	v_cvt_pk_bf16_f32 v123, v102, v103
	v_lshlrev_b32 v96, 16, v120
	v_and_b32 v97, 0xffff0000, v120
	v_lshlrev_b32 v98, 16, v121
	v_and_b32 v99, 0xffff0000, v121
	v_lshlrev_b32 v100, 16, v122
	v_and_b32 v101, 0xffff0000, v122
	v_lshlrev_b32 v102, 16, v123
	v_and_b32 v103, 0xffff0000, v123
	v_mul_f32 v96, s57, v96
	v_mul_f32 v97, s57, v97
	v_mul_f32 v98, s57, v98
	v_mul_f32 v99, s57, v99
	v_mul_f32 v100, s57, v100
	v_mul_f32 v101, s57, v101
	v_mul_f32 v102, s57, v102
	v_mul_f32 v103, s57, v103
	v_cvt_pk_bf16_f32 v56, v88, v96
	v_cvt_pk_bf16_f32 v57, v89, v97
	v_cvt_pk_bf16_f32 v58, v90, v98
	v_cvt_pk_bf16_f32 v59, v91, v99
	v_cvt_pk_bf16_f32 v60, v92, v100
	v_cvt_pk_bf16_f32 v61, v93, v101
	v_cvt_pk_bf16_f32 v62, v94, v102
	v_cvt_pk_bf16_f32 v63, v95, v103
	ds_write_b128 v189, v[56:59]
	ds_write_b128 v189, v[60:63] offset:16
	s_waitcnt lgkmcnt(0)
	s_barrier
	ds_read_b32 v64, v190 offset:0
	ds_read_b32 v65, v190 offset:2048
	ds_read_b32 v66, v190 offset:4096
	ds_read_b32 v67, v190 offset:6144
	ds_read_b32 v68, v190 offset:1024
	ds_read_b32 v69, v190 offset:3072
	ds_read_b32 v70, v190 offset:5120
	ds_read_b32 v71, v190 offset:7168
	v_lshlrev_b32 v4, 4, v0
	v_add_u32 v5, 0x1000, v4
	s_waitcnt vmcnt(23)
	s_waitcnt vmcnt(12)
	s_waitcnt lgkmcnt(4)
	global_store_dwordx4 v4, v[64:67], s[48:49] sc1
	s_waitcnt lgkmcnt(0)
	global_store_dwordx4 v5, v[68:71], s[48:49] sc1
	s_bitcmp1_b32 0x3fdeff, s98
	s_cbranch_scc0 Lj_74
	s_mov_b32 m0, s99
	s_nop 0
	global_load_lds_dwordx4 v16, s[64:65]
	s_add_u32 m0, m0, 0x400
	s_nop 0
	global_load_lds_dwordx4 v17, s[64:65]
	s_add_u32 m0, m0, 0x400
	s_nop 0
	global_load_lds_dwordx4 v18, s[64:65]
	s_bitcmp1_b32 0x3fc0ff, s98
	s_cbranch_scc1 Lj3_75
	s_add_u32 m0, m0, 0x400
	s_nop 0
	global_load_lds_dwordx4 v19, s[64:65]
Lj3_75:
	s_add_u32 s64, s64, s101
	s_addc_u32 s65, s65, 0
	s_add_u32 s99, s99, s0
	s_add_u32 s98, s98, 1
Lj_74:
	s_lshr_b32 s36, s2, 3
	s_mul_i32 s36, s36, 112
	v_min_u32 v4, 111, v0
	v_add_u32 v4, s36, v4
	v_lshrrev_b32 v5, 2, v4
	v_mul_u32_u24 v6, 0x924a, v5
	v_lshrrev_b32 v6, 23, v6
	v_mul_u32_u24 v6, 128, v6
	v_add_u32 v5, v6, v5
	v_add_u32 v5, 128, v5
	v_and_b32 v4, 3, v4
	v_min_u32 v5, 0x55f, v5
	v_lshlrev_b32 v5, 12, v5
	v_lshl_add_u32 v4, v4, 7, v5
	s_and_b32 s36, s2, 7
	s_lshl_b32 s36, s36, 9
	v_add_u32 v4, s36, v4
	global_load_dword v23, v4, s[16:17]
	s_bitcmp1_b32 0x402100, s98
	s_cbranch_scc0 Ltr_76
	s_mov_b32 s63, 3
	s_waitcnt vmcnt(1)
	s_cmp_eq_u32 s98, 8
	s_cbranch_scc1 LT_51
	s_cmp_eq_u32 s98, 13
	s_cbranch_scc1 LT_52
	s_branch LT_53
Ltr_76:
	s_barrier
	s_lshl_b32 s36, s96, 1
	v_lshlrev_b32 v4, 4, v3
	v_lshlrev_b32 v5, 3, v3
	s_add_u32 s34, s14, s36
	s_addc_u32 s35, s15, 0
	global_load_dwordx4 v[32:35], v4, s[34:35]
	global_load_dwordx2 v[36:37], v5, s[34:35] offset:64
	v_lshlrev_b32 v4, 13, v3
	s_lshl_b32 s36, s97, 10
	v_lshl_add_u32 v4, v2, 4, v4
	v_add_u32 v4, s36, v4
	s_xor_b32 s36, s3, 0
	s_lshl_b32 s36, s36, 8
	v_add_u32 v24, s36, v4
	s_xor_b32 s36, s3, 1
	s_lshl_b32 s36, s36, 8
	v_add_u32 v25, s36, v4
	s_xor_b32 s36, s3, 2
	s_lshl_b32 s36, s36, 8
	v_add_u32 v26, s36, v4
	s_xor_b32 s36, s3, 3
	s_lshl_b32 s36, s36, 8
	v_add_u32 v27, s36, v4
	s_lshl_b32 s36, s3, 19
	s_add_u32 s56, s24, s36
	s_addc_u32 s57, s25, 0
	s_add_u32 s56, s56, 9437184
	s_addc_u32 s57, s57, 0
	s_xor_b32 s36, s3, 1
	s_mul_i32 s36, s36, 9216
	s_add_u32 s36, s36, 126976
	v_add_u32 v28, s36, v21
	s_xor_b32 s36, s3, 2
	s_mul_i32 s36, s36, 9216
	s_add_u32 s36, s36, 130048
	v_add_u32 v29, s36, v21
	s_xor_b32 s36, s3, 3
	s_mul_i32 s36, s36, 9216
	s_add_u32 s36, s36, 133120
	v_add_u32 v30, s36, v21
	s_mul_i32 s36, s3, 9216
	s_add_u32 s36, s36, 126976
	v_add_u32 v31, s36, v21
	v_bfe_u32 v4, v2, 2, 1
	v_lshlrev_b32 v4, 4, v4
	v_lshrrev_b32 v5, 3, v2
	v_lshl_add_u32 v4, v5, 2, v4
	v_and_b32 v5, 3, v2
	v_add_u32 v4, v4, v5
	s_lshr_b32 s36, s3, 1
	s_lshl_b32 s36, s36, 5
	s_and_b32 s37, s3, 1
	s_lshl_b32 s37, s37, 3
	s_add_u32 s36, s36, s37
	v_add_u32 v4, s36, v4
	v_lshlrev_b32 v4, 4, v4
	v_lshl_add_u32 v38, v3, 13, v4
	v_lshrrev_b32 v5, 1, v3
	v_add_u32 v5, 4, v5
	v_lshl_add_u32 v39, v5, 13, v4
	s_lshl_b32 s36, s96, 10
	s_lshl_b32 s37, s97, 10
	s_add_u32 s36, s36, s37
	s_add_u32 s58, s24, s36
	s_addc_u32 s59, s25, 0
	s_add_u32 s58, s58, 11534336
	s_addc_u32 s59, s59, 0
	s_mov_b32 s28, 0
	s_cmp_ge_u32 s98, 23
	s_cbranch_scc1 Ljd_95
Ljf_94:
	s_bitcmp1_b32 0x402100, s98
	s_cbranch_scc0 Ltr_96
	s_mov_b32 s63, 0
	s_waitcnt vmcnt(0)
	s_cmp_eq_u32 s98, 8
	s_cbranch_scc1 LT_97
	s_cmp_eq_u32 s98, 13
	s_cbranch_scc1 LT_98
	s_branch LT_99
Ltr_96:
	s_bitcmp1_b32 0x3fdeff, s98
	s_cbranch_scc0 Lj_100
	s_mov_b32 m0, s99
	s_nop 0
	global_load_lds_dwordx4 v16, s[64:65]
	s_add_u32 m0, m0, 0x400
	s_nop 0
	global_load_lds_dwordx4 v17, s[64:65]
	s_add_u32 m0, m0, 0x400
	s_nop 0
	global_load_lds_dwordx4 v18, s[64:65]
	s_bitcmp1_b32 0x3fc0ff, s98
	s_cbranch_scc1 Lj3_101
	s_add_u32 m0, m0, 0x400
	s_nop 0
	global_load_lds_dwordx4 v19, s[64:65]
Lj3_101:
	s_add_u32 s64, s64, s101
	s_addc_u32 s65, s65, 0
	s_add_u32 s99, s99, s0
	s_add_u32 s98, s98, 1
Lj_100:
	s_cmp_lt_u32 s98, 23
	s_cbranch_scc1 Ljf_94
	s_waitcnt vmcnt(0)
Ljd_95:
	s_add_u32 s40, s56, 0
	s_addc_u32 s41, s57, 0
	global_load_dwordx4 v[128:131], v24, s[40:41] sc1
	global_load_dwordx4 v[132:135], v25, s[40:41] sc1
	global_load_dwordx4 v[136:139], v26, s[40:41] sc1
	global_load_dwordx4 v[140:143], v27, s[40:41] sc1
	s_add_u32 s42, s56, 32768
	s_addc_u32 s43, s57, 0
	global_load_dwordx4 v[144:147], v24, s[42:43] sc1
	global_load_dwordx4 v[148:151], v25, s[42:43] sc1
	global_load_dwordx4 v[152:155], v26, s[42:43] sc1
	global_load_dwordx4 v[156:159], v27, s[42:43] sc1
	s_add_u32 s44, s56, 65536
	s_addc_u32 s45, s57, 0
	global_load_dwordx4 v[160:163], v24, s[44:45] sc1
	global_load_dwordx4 v[164:167], v25, s[44:45] sc1
	global_load_dwordx4 v[168:171], v26, s[44:45] sc1
	global_load_dwordx4 v[172:175], v27, s[44:45] sc1
	s_add_u32 s46, s56, 98304
	s_addc_u32 s47, s57, 0
	global_load_dwordx4 v[176:179], v24, s[46:47] sc1
	global_load_dwordx4 v[180:183], v25, s[46:47] sc1
	global_load_dwordx4 v[184:187], v26, s[46:47] sc1
	global_load_dwordx4 v[188:191], v27, s[46:47] sc1
	s_add_u32 s48, s56, 131072
	s_addc_u32 s49, s57, 0
	global_load_dwordx4 v[192:195], v24, s[48:49] sc1
	global_load_dwordx4 v[196:199], v25, s[48:49] sc1
	global_load_dwordx4 v[200:203], v26, s[48:49] sc1
	global_load_dwordx4 v[204:207], v27, s[48:49] sc1
	s_bitcmp1_b32 0x402100, s98
	s_cbranch_scc0 Ltr_102
	s_mov_b32 s63, 1
	s_waitcnt vmcnt(20)
	s_cmp_eq_u32 s98, 8
	s_cbranch_scc1 LT_97
	s_cmp_eq_u32 s98, 13
	s_cbranch_scc1 LT_98
	s_branch LT_99
Ltr_102:
	s_waitcnt vmcnt(16)
	v_max3_u32 v8, v128, v132, v136
	v_max_u32 v8, v8, v140
	v_cmp_eq_u32 vcc, -1, v8
	s_cbranch_vccnz Lfs_105
Lfd_104:
	s_mov_b32 s29, 0
	s_waitcnt vmcnt(16)
	v_max3_u32 v8, v128, v132, v136
	v_max_u32 v8, v8, v140
	v_cmp_eq_u32 vcc, -1, v8
	s_cbranch_vccnz Lrep1_77
Lret1_78:
	s_add_u32 s50, s56, 163840
	s_addc_u32 s51, s57, 0
	v_mfma_f32_16x16x32_bf16 v[64:67], a[0:3], v[128:131], 0
	global_load_dwordx4 v[208:211], v24, s[50:51] sc1
	v_mfma_f32_16x16x32_bf16 v[80:83], a[4:7], v[128:131], 0
	v_mfma_f32_16x16x32_bf16 v[96:99], a[8:11], v[128:131], 0
	v_mfma_f32_16x16x32_bf16 v[68:71], a[0:3], v[132:135], 0
	global_load_dwordx4 v[212:215], v25, s[50:51] sc1
	v_mfma_f32_16x16x32_bf16 v[84:87], a[4:7], v[132:135], 0
	v_mfma_f32_16x16x32_bf16 v[100:103], a[8:11], v[132:135], 0
	v_mfma_f32_16x16x32_bf16 v[72:75], a[0:3], v[136:139], 0
	global_load_dwordx4 v[216:219], v26, s[50:51] sc1
	v_mfma_f32_16x16x32_bf16 v[88:91], a[4:7], v[136:139], 0
	v_mfma_f32_16x16x32_bf16 v[104:107], a[8:11], v[136:139], 0
	v_mfma_f32_16x16x32_bf16 v[76:79], a[0:3], v[140:143], 0
	global_load_dwordx4 v[220:223], v27, s[50:51] sc1
	v_mfma_f32_16x16x32_bf16 v[92:95], a[4:7], v[140:143], 0
	v_mfma_f32_16x16x32_bf16 v[108:111], a[8:11], v[140:143], 0
	s_mov_b32 s29, 1
	s_waitcnt vmcnt(16)
	v_max3_u32 v8, v144, v148, v152
	v_max_u32 v8, v8, v156
	v_cmp_eq_u32 vcc, -1, v8
	s_cbranch_vccnz Lrep1_77
Lret1_79:
	s_add_u32 s52, s56, 196608
	s_addc_u32 s53, s57, 0
	v_mfma_f32_16x16x32_bf16 v[64:67], a[12:15], v[144:147], v[64:67]
	global_load_dwordx4 v[224:227], v24, s[52:53] sc1
	v_mfma_f32_16x16x32_bf16 v[80:83], a[16:19], v[144:147], v[80:83]
	v_mfma_f32_16x16x32_bf16 v[96:99], a[20:23], v[144:147], v[96:99]
	v_mfma_f32_16x16x32_bf16 v[68:71], a[12:15], v[148:151], v[68:71]
	global_load_dwordx4 v[228:231], v25, s[52:53] sc1
	v_mfma_f32_16x16x32_bf16 v[84:87], a[16:19], v[148:151], v[84:87]
	v_mfma_f32_16x16x32_bf16 v[100:103], a[20:23], v[148:151], v[100:103]
	v_mfma_f32_16x16x32_bf16 v[72:75], a[12:15], v[152:155], v[72:75]
	global_load_dwordx4 v[232:235], v26, s[52:53] sc1
	v_mfma_f32_16x16x32_bf16 v[88:91], a[16:19], v[152:155], v[88:91]
	v_mfma_f32_16x16x32_bf16 v[104:107], a[20:23], v[152:155], v[104:107]
	v_mfma_f32_16x16x32_bf16 v[76:79], a[12:15], v[156:159], v[76:79]
	global_load_dwordx4 v[236:239], v27, s[52:53] sc1
	v_mfma_f32_16x16x32_bf16 v[92:95], a[16:19], v[156:159], v[92:95]
	v_mfma_f32_16x16x32_bf16 v[108:111], a[20:23], v[156:159], v[108:111]
	s_mov_b32 s29, 2
	s_waitcnt vmcnt(16)
	v_max3_u32 v8, v160, v164, v168
	v_max_u32 v8, v8, v172
	v_cmp_eq_u32 vcc, -1, v8
	s_cbranch_vccnz Lrep1_77
Lret1_80:
	s_add_u32 s54, s56, 229376
	s_addc_u32 s55, s57, 0
	v_mfma_f32_16x16x32_bf16 v[64:67], a[24:27], v[160:163], v[64:67]
	global_load_dwordx4 v[240:243], v24, s[54:55] sc1
	v_mfma_f32_16x16x32_bf16 v[80:83], a[28:31], v[160:163], v[80:83]
	v_mfma_f32_16x16x32_bf16 v[96:99], a[32:35], v[160:163], v[96:99]
	v_mfma_f32_16x16x32_bf16 v[68:71], a[24:27], v[164:167], v[68:71]
	global_load_dwordx4 v[244:247], v25, s[54:55] sc1
	v_mfma_f32_16x16x32_bf16 v[84:87], a[28:31], v[164:167], v[84:87]
	v_mfma_f32_16x16x32_bf16 v[100:103], a[32:35], v[164:167], v[100:103]
	v_mfma_f32_16x16x32_bf16 v[72:75], a[24:27], v[168:171], v[72:75]
	global_load_dwordx4 v[248:251], v26, s[54:55] sc1
	v_mfma_f32_16x16x32_bf16 v[88:91], a[28:31], v[168:171], v[88:91]
	v_mfma_f32_16x16x32_bf16 v[104:107], a[32:35], v[168:171], v[104:107]
	v_mfma_f32_16x16x32_bf16 v[76:79], a[24:27], v[172:175], v[76:79]
	global_load_dwordx4 v[252:255], v27, s[54:55] sc1
	v_mfma_f32_16x16x32_bf16 v[92:95], a[28:31], v[172:175], v[92:95]
	v_mfma_f32_16x16x32_bf16 v[108:111], a[32:35], v[172:175], v[108:111]
	s_mov_b32 s29, 3
	s_waitcnt vmcnt(16)
	v_max3_u32 v8, v176, v180, v184
	v_max_u32 v8, v8, v188
	v_cmp_eq_u32 vcc, -1, v8
	s_cbranch_vccnz Lrep1_77
Lret1_81:
	s_add_u32 s40, s56, 262144
	s_addc_u32 s41, s57, 0
	v_mfma_f32_16x16x32_bf16 v[64:67], a[36:39], v[176:179], v[64:67]
	global_load_dwordx4 v[128:131], v24, s[40:41] sc1
	v_mfma_f32_16x16x32_bf16 v[80:83], a[40:43], v[176:179], v[80:83]
	v_mfma_f32_16x16x32_bf16 v[96:99], a[44:47], v[176:179], v[96:99]
	v_mfma_f32_16x16x32_bf16 v[68:71], a[36:39], v[180:183], v[68:71]
	global_load_dwordx4 v[132:135], v25, s[40:41] sc1
	v_mfma_f32_16x16x32_bf16 v[84:87], a[40:43], v[180:183], v[84:87]
	v_mfma_f32_16x16x32_bf16 v[100:103], a[44:47], v[180:183], v[100:103]
	v_mfma_f32_16x16x32_bf16 v[72:75], a[36:39], v[184:187], v[72:75]
	global_load_dwordx4 v[136:139], v26, s[40:41] sc1
	v_mfma_f32_16x16x32_bf16 v[88:91], a[40:43], v[184:187], v[88:91]
	v_mfma_f32_16x16x32_bf16 v[104:107], a[44:47], v[184:187], v[104:107]
	v_mfma_f32_16x16x32_bf16 v[76:79], a[36:39], v[188:191], v[76:79]
	global_load_dwordx4 v[140:143], v27, s[40:41] sc1
	v_mfma_f32_16x16x32_bf16 v[92:95], a[40:43], v[188:191], v[92:95]
	v_mfma_f32_16x16x32_bf16 v[108:111], a[44:47], v[188:191], v[108:111]
	s_mov_b32 s29, 4
	s_waitcnt vmcnt(16)
	v_max3_u32 v8, v192, v196, v200
	v_max_u32 v8, v8, v204
	v_cmp_eq_u32 vcc, -1, v8
	s_cbranch_vccnz Lrep1_77
Lret1_82:
	s_add_u32 s42, s56, 294912
	s_addc_u32 s43, s57, 0
	v_mfma_f32_16x16x32_bf16 v[64:67], a[48:51], v[192:195], v[64:67]
	global_load_dwordx4 v[144:147], v24, s[42:43] sc1
	v_mfma_f32_16x16x32_bf16 v[80:83], a[52:55], v[192:195], v[80:83]
	v_mfma_f32_16x16x32_bf16 v[96:99], a[56:59], v[192:195], v[96:99]
	v_mfma_f32_16x16x32_bf16 v[68:71], a[48:51], v[196:199], v[68:71]
	global_load_dwordx4 v[148:151], v25, s[42:43] sc1
	v_mfma_f32_16x16x32_bf16 v[84:87], a[52:55], v[196:199], v[84:87]
	v_mfma_f32_16x16x32_bf16 v[100:103], a[56:59], v[196:199], v[100:103]
	v_mfma_f32_16x16x32_bf16 v[72:75], a[48:51], v[200:203], v[72:75]
	global_load_dwordx4 v[152:155], v26, s[42:43] sc1
	v_mfma_f32_16x16x32_bf16 v[88:91], a[52:55], v[200:203], v[88:91]
	v_mfma_f32_16x16x32_bf16 v[104:107], a[56:59], v[200:203], v[104:107]
	v_mfma_f32_16x16x32_bf16 v[76:79], a[48:51], v[204:207], v[76:79]
	global_load_dwordx4 v[156:159], v27, s[42:43] sc1
	v_mfma_f32_16x16x32_bf16 v[92:95], a[52:55], v[204:207], v[92:95]
	v_mfma_f32_16x16x32_bf16 v[108:111], a[56:59], v[204:207], v[108:111]
	s_mov_b32 s29, 5
	s_waitcnt vmcnt(16)
	v_max3_u32 v8, v208, v212, v216
	v_max_u32 v8, v8, v220
	v_cmp_eq_u32 vcc, -1, v8
	s_cbranch_vccnz Lrep1_77
Lret1_83:
	s_add_u32 s44, s56, 327680
	s_addc_u32 s45, s57, 0
	v_mfma_f32_16x16x32_bf16 v[64:67], a[60:63], v[208:211], v[64:67]
	global_load_dwordx4 v[160:163], v24, s[44:45] sc1
	v_mfma_f32_16x16x32_bf16 v[80:83], a[64:67], v[208:211], v[80:83]
	v_mfma_f32_16x16x32_bf16 v[96:99], a[68:71], v[208:211], v[96:99]
	v_mfma_f32_16x16x32_bf16 v[68:71], a[60:63], v[212:215], v[68:71]
	global_load_dwordx4 v[164:167], v25, s[44:45] sc1
	v_mfma_f32_16x16x32_bf16 v[84:87], a[64:67], v[212:215], v[84:87]
	v_mfma_f32_16x16x32_bf16 v[100:103], a[68:71], v[212:215], v[100:103]
	v_mfma_f32_16x16x32_bf16 v[72:75], a[60:63], v[216:219], v[72:75]
	global_load_dwordx4 v[168:171], v26, s[44:45] sc1
	v_mfma_f32_16x16x32_bf16 v[88:91], a[64:67], v[216:219], v[88:91]
	v_mfma_f32_16x16x32_bf16 v[104:107], a[68:71], v[216:219], v[104:107]
	v_mfma_f32_16x16x32_bf16 v[76:79], a[60:63], v[220:223], v[76:79]
	global_load_dwordx4 v[172:175], v27, s[44:45] sc1
	v_mfma_f32_16x16x32_bf16 v[92:95], a[64:67], v[220:223], v[92:95]
	v_mfma_f32_16x16x32_bf16 v[108:111], a[68:71], v[220:223], v[108:111]
	s_mov_b32 s29, 6
	s_waitcnt vmcnt(16)
	v_max3_u32 v8, v224, v228, v232
	v_max_u32 v8, v8, v236
	v_cmp_eq_u32 vcc, -1, v8
	s_cbranch_vccnz Lrep1_77
Lret1_84:
	s_add_u32 s46, s56, 360448
	s_addc_u32 s47, s57, 0
	v_mfma_f32_16x16x32_bf16 v[64:67], a[72:75], v[224:227], v[64:67]
	global_load_dwordx4 v[176:179], v24, s[46:47] sc1
	v_mfma_f32_16x16x32_bf16 v[80:83], a[76:79], v[224:227], v[80:83]
	v_mfma_f32_16x16x32_bf16 v[96:99], a[80:83], v[224:227], v[96:99]
	v_mfma_f32_16x16x32_bf16 v[68:71], a[72:75], v[228:231], v[68:71]
	global_load_dwordx4 v[180:183], v25, s[46:47] sc1
	v_mfma_f32_16x16x32_bf16 v[84:87], a[76:79], v[228:231], v[84:87]
	v_mfma_f32_16x16x32_bf16 v[100:103], a[80:83], v[228:231], v[100:103]
	v_mfma_f32_16x16x32_bf16 v[72:75], a[72:75], v[232:235], v[72:75]
	global_load_dwordx4 v[184:187], v26, s[46:47] sc1
	v_mfma_f32_16x16x32_bf16 v[88:91], a[76:79], v[232:235], v[88:91]
	v_mfma_f32_16x16x32_bf16 v[104:107], a[80:83], v[232:235], v[104:107]
	v_mfma_f32_16x16x32_bf16 v[76:79], a[72:75], v[236:239], v[76:79]
	global_load_dwordx4 v[188:191], v27, s[46:47] sc1
	v_mfma_f32_16x16x32_bf16 v[92:95], a[76:79], v[236:239], v[92:95]
	v_mfma_f32_16x16x32_bf16 v[108:111], a[80:83], v[236:239], v[108:111]
	s_mov_b32 s29, 7
	s_waitcnt vmcnt(16)
	v_max3_u32 v8, v240, v244, v248
	v_max_u32 v8, v8, v252
	v_cmp_eq_u32 vcc, -1, v8
	s_cbranch_vccnz Lrep1_77
Lret1_85:
	s_add_u32 s48, s56, 393216
	s_addc_u32 s49, s57, 0
	v_mfma_f32_16x16x32_bf16 v[64:67], a[84:87], v[240:243], v[64:67]
	global_load_dwordx4 v[192:195], v24, s[48:49] sc1
	v_mfma_f32_16x16x32_bf16 v[80:83], a[88:91], v[240:243], v[80:83]
	v_mfma_f32_16x16x32_bf16 v[96:99], a[92:95], v[240:243], v[96:99]
	v_mfma_f32_16x16x32_bf16 v[68:71], a[84:87], v[244:247], v[68:71]
	global_load_dwordx4 v[196:199], v25, s[48:49] sc1
	v_mfma_f32_16x16x32_bf16 v[84:87], a[88:91], v[244:247], v[84:87]
	v_mfma_f32_16x16x32_bf16 v[100:103], a[92:95], v[244:247], v[100:103]
	v_mfma_f32_16x16x32_bf16 v[72:75], a[84:87], v[248:251], v[72:75]
	global_load_dwordx4 v[200:203], v26, s[48:49] sc1
	v_mfma_f32_16x16x32_bf16 v[88:91], a[88:91], v[248:251], v[88:91]
	v_mfma_f32_16x16x32_bf16 v[104:107], a[92:95], v[248:251], v[104:107]
	v_mfma_f32_16x16x32_bf16 v[76:79], a[84:87], v[252:255], v[76:79]
	global_load_dwordx4 v[204:207], v27, s[48:49] sc1
	v_mfma_f32_16x16x32_bf16 v[92:95], a[88:91], v[252:255], v[92:95]
	v_mfma_f32_16x16x32_bf16 v[108:111], a[92:95], v[252:255], v[108:111]
	s_mov_b32 s29, 8
	s_waitcnt vmcnt(16)
	v_max3_u32 v8, v128, v132, v136
	v_max_u32 v8, v8, v140
	v_cmp_eq_u32 vcc, -1, v8
	s_cbranch_vccnz Lrep1_77
Lret1_86:
	s_add_u32 s50, s56, 425984
	s_addc_u32 s51, s57, 0
	v_mfma_f32_16x16x32_bf16 v[64:67], a[96:99], v[128:131], v[64:67]
	global_load_dwordx4 v[208:211], v24, s[50:51] sc1
	v_mfma_f32_16x16x32_bf16 v[80:83], a[100:103], v[128:131], v[80:83]
	v_mfma_f32_16x16x32_bf16 v[96:99], a[104:107], v[128:131], v[96:99]
	v_mfma_f32_16x16x32_bf16 v[68:71], a[96:99], v[132:135], v[68:71]
	global_load_dwordx4 v[212:215], v25, s[50:51] sc1
	v_mfma_f32_16x16x32_bf16 v[84:87], a[100:103], v[132:135], v[84:87]
	v_mfma_f32_16x16x32_bf16 v[100:103], a[104:107], v[132:135], v[100:103]
	v_mfma_f32_16x16x32_bf16 v[72:75], a[96:99], v[136:139], v[72:75]
	global_load_dwordx4 v[216:219], v26, s[50:51] sc1
	v_mfma_f32_16x16x32_bf16 v[88:91], a[100:103], v[136:139], v[88:91]
	v_mfma_f32_16x16x32_bf16 v[104:107], a[104:107], v[136:139], v[104:107]
	v_mfma_f32_16x16x32_bf16 v[76:79], a[96:99], v[140:143], v[76:79]
	global_load_dwordx4 v[220:223], v27, s[50:51] sc1
	v_mfma_f32_16x16x32_bf16 v[92:95], a[100:103], v[140:143], v[92:95]
	v_mfma_f32_16x16x32_bf16 v[108:111], a[104:107], v[140:143], v[108:111]
	s_mov_b32 s29, 9
	s_waitcnt vmcnt(16)
	v_max3_u32 v8, v144, v148, v152
	v_max_u32 v8, v8, v156
	v_cmp_eq_u32 vcc, -1, v8
	s_cbranch_vccnz Lrep1_77
Lret1_87:
	s_add_u32 s52, s56, 458752
	s_addc_u32 s53, s57, 0
	v_mfma_f32_16x16x32_bf16 v[64:67], a[108:111], v[144:147], v[64:67]
	global_load_dwordx4 v[224:227], v24, s[52:53] sc1
	v_mfma_f32_16x16x32_bf16 v[80:83], a[112:115], v[144:147], v[80:83]
	v_mfma_f32_16x16x32_bf16 v[96:99], a[116:119], v[144:147], v[96:99]
	v_mfma_f32_16x16x32_bf16 v[68:71], a[108:111], v[148:151], v[68:71]
	global_load_dwordx4 v[228:231], v25, s[52:53] sc1
	v_mfma_f32_16x16x32_bf16 v[84:87], a[112:115], v[148:151], v[84:87]
	v_mfma_f32_16x16x32_bf16 v[100:103], a[116:119], v[148:151], v[100:103]
	v_mfma_f32_16x16x32_bf16 v[72:75], a[108:111], v[152:155], v[72:75]
	global_load_dwordx4 v[232:235], v26, s[52:53] sc1
	v_mfma_f32_16x16x32_bf16 v[88:91], a[112:115], v[152:155], v[88:91]
	v_mfma_f32_16x16x32_bf16 v[104:107], a[116:119], v[152:155], v[104:107]
	v_mfma_f32_16x16x32_bf16 v[76:79], a[108:111], v[156:159], v[76:79]
	global_load_dwordx4 v[236:239], v27, s[52:53] sc1
	v_mfma_f32_16x16x32_bf16 v[92:95], a[112:115], v[156:159], v[92:95]
	v_mfma_f32_16x16x32_bf16 v[108:111], a[116:119], v[156:159], v[108:111]
	s_mov_b32 s29, 10
	s_waitcnt vmcnt(16)
	v_max3_u32 v8, v160, v164, v168
	v_max_u32 v8, v8, v172
	v_cmp_eq_u32 vcc, -1, v8
	s_cbranch_vccnz Lrep1_77
Lret1_88:
	s_add_u32 s54, s56, 491520
	s_addc_u32 s55, s57, 0
	v_mfma_f32_16x16x32_bf16 v[64:67], a[120:123], v[160:163], v[64:67]
	global_load_dwordx4 v[240:243], v24, s[54:55] sc1
	v_mfma_f32_16x16x32_bf16 v[80:83], a[124:127], v[160:163], v[80:83]
	v_mfma_f32_16x16x32_bf16 v[96:99], a[128:131], v[160:163], v[96:99]
	v_mfma_f32_16x16x32_bf16 v[68:71], a[120:123], v[164:167], v[68:71]
	global_load_dwordx4 v[244:247], v25, s[54:55] sc1
	v_mfma_f32_16x16x32_bf16 v[84:87], a[124:127], v[164:167], v[84:87]
	v_mfma_f32_16x16x32_bf16 v[100:103], a[128:131], v[164:167], v[100:103]
	v_mfma_f32_16x16x32_bf16 v[72:75], a[120:123], v[168:171], v[72:75]
	global_load_dwordx4 v[248:251], v26, s[54:55] sc1
	v_mfma_f32_16x16x32_bf16 v[88:91], a[124:127], v[168:171], v[88:91]
	v_mfma_f32_16x16x32_bf16 v[104:107], a[128:131], v[168:171], v[104:107]
	v_mfma_f32_16x16x32_bf16 v[76:79], a[120:123], v[172:175], v[76:79]
	global_load_dwordx4 v[252:255], v27, s[54:55] sc1
	v_mfma_f32_16x16x32_bf16 v[92:95], a[124:127], v[172:175], v[92:95]
	v_mfma_f32_16x16x32_bf16 v[108:111], a[128:131], v[172:175], v[108:111]
	s_mov_b32 s29, 11
	s_waitcnt vmcnt(16)
	v_max3_u32 v8, v176, v180, v184
	v_max_u32 v8, v8, v188
	v_cmp_eq_u32 vcc, -1, v8
	s_cbranch_vccnz Lrep1_77
Lret1_89:
	v_mfma_f32_16x16x32_bf16 v[64:67], a[132:135], v[176:179], v[64:67]
	v_mfma_f32_16x16x32_bf16 v[80:83], a[136:139], v[176:179], v[80:83]
	v_mfma_f32_16x16x32_bf16 v[96:99], a[140:143], v[176:179], v[96:99]
	v_mfma_f32_16x16x32_bf16 v[68:71], a[132:135], v[180:183], v[68:71]
	v_mfma_f32_16x16x32_bf16 v[84:87], a[136:139], v[180:183], v[84:87]
	v_mfma_f32_16x16x32_bf16 v[100:103], a[140:143], v[180:183], v[100:103]
	v_mfma_f32_16x16x32_bf16 v[72:75], a[132:135], v[184:187], v[72:75]
	v_mfma_f32_16x16x32_bf16 v[88:91], a[136:139], v[184:187], v[88:91]
	v_mfma_f32_16x16x32_bf16 v[104:107], a[140:143], v[184:187], v[104:107]
	v_mfma_f32_16x16x32_bf16 v[76:79], a[132:135], v[188:191], v[76:79]
	v_mfma_f32_16x16x32_bf16 v[92:95], a[136:139], v[188:191], v[92:95]
	v_mfma_f32_16x16x32_bf16 v[108:111], a[140:143], v[188:191], v[108:111]
	s_mov_b32 s29, 12
	s_waitcnt vmcnt(12)
	v_max3_u32 v8, v192, v196, v200
	v_max_u32 v8, v8, v204
	v_cmp_eq_u32 vcc, -1, v8
	s_cbranch_vccnz Lrep1_77
Lret1_90:
	v_mfma_f32_16x16x32_bf16 v[64:67], a[144:147], v[192:195], v[64:67]
	v_mfma_f32_16x16x32_bf16 v[80:83], a[148:151], v[192:195], v[80:83]
	v_mfma_f32_16x16x32_bf16 v[96:99], a[152:155], v[192:195], v[96:99]
	v_mfma_f32_16x16x32_bf16 v[68:71], a[144:147], v[196:199], v[68:71]
	v_mfma_f32_16x16x32_bf16 v[84:87], a[148:151], v[196:199], v[84:87]
	v_mfma_f32_16x16x32_bf16 v[100:103], a[152:155], v[196:199], v[100:103]
	v_mfma_f32_16x16x32_bf16 v[72:75], a[144:147], v[200:203], v[72:75]
	v_mfma_f32_16x16x32_bf16 v[88:91], a[148:151], v[200:203], v[88:91]
	v_mfma_f32_16x16x32_bf16 v[104:107], a[152:155], v[200:203], v[104:107]
	v_mfma_f32_16x16x32_bf16 v[76:79], a[144:147], v[204:207], v[76:79]
	v_mfma_f32_16x16x32_bf16 v[92:95], a[148:151], v[204:207], v[92:95]
	v_mfma_f32_16x16x32_bf16 v[108:111], a[152:155], v[204:207], v[108:111]
	s_mov_b32 s29, 13
	s_waitcnt vmcnt(8)
	v_max3_u32 v8, v208, v212, v216
	v_max_u32 v8, v8, v220
	v_cmp_eq_u32 vcc, -1, v8
	s_cbranch_vccnz Lrep1_77
Lret1_91:
	v_mfma_f32_16x16x32_bf16 v[64:67], a[156:159], v[208:211], v[64:67]
	v_mfma_f32_16x16x32_bf16 v[80:83], a[160:163], v[208:211], v[80:83]
	v_mfma_f32_16x16x32_bf16 v[96:99], a[164:167], v[208:211], v[96:99]
	v_mfma_f32_16x16x32_bf16 v[68:71], a[156:159], v[212:215], v[68:71]
	v_mfma_f32_16x16x32_bf16 v[84:87], a[160:163], v[212:215], v[84:87]
	v_mfma_f32_16x16x32_bf16 v[100:103], a[164:167], v[212:215], v[100:103]
	v_mfma_f32_16x16x32_bf16 v[72:75], a[156:159], v[216:219], v[72:75]
	v_mfma_f32_16x16x32_bf16 v[88:91], a[160:163], v[216:219], v[88:91]
	v_mfma_f32_16x16x32_bf16 v[104:107], a[164:167], v[216:219], v[104:107]
	v_mfma_f32_16x16x32_bf16 v[76:79], a[156:159], v[220:223], v[76:79]
	v_mfma_f32_16x16x32_bf16 v[92:95], a[160:163], v[220:223], v[92:95]
	v_mfma_f32_16x16x32_bf16 v[108:111], a[164:167], v[220:223], v[108:111]
	s_mov_b32 s29, 14
	s_waitcnt vmcnt(4)
	v_max3_u32 v8, v224, v228, v232
	v_max_u32 v8, v8, v236
	v_cmp_eq_u32 vcc, -1, v8
	s_cbranch_vccnz Lrep1_77
Lret1_92:
	v_mfma_f32_16x16x32_bf16 v[64:67], a[168:171], v[224:227], v[64:67]
	v_mfma_f32_16x16x32_bf16 v[80:83], a[172:175], v[224:227], v[80:83]
	v_mfma_f32_16x16x32_bf16 v[96:99], a[176:179], v[224:227], v[96:99]
	v_mfma_f32_16x16x32_bf16 v[68:71], a[168:171], v[228:231], v[68:71]
	v_mfma_f32_16x16x32_bf16 v[84:87], a[172:175], v[228:231], v[84:87]
	v_mfma_f32_16x16x32_bf16 v[100:103], a[176:179], v[228:231], v[100:103]
	v_mfma_f32_16x16x32_bf16 v[72:75], a[168:171], v[232:235], v[72:75]
	v_mfma_f32_16x16x32_bf16 v[88:91], a[172:175], v[232:235], v[88:91]
	v_mfma_f32_16x16x32_bf16 v[104:107], a[176:179], v[232:235], v[104:107]
	v_mfma_f32_16x16x32_bf16 v[76:79], a[168:171], v[236:239], v[76:79]
	v_mfma_f32_16x16x32_bf16 v[92:95], a[172:175], v[236:239], v[92:95]
	v_mfma_f32_16x16x32_bf16 v[108:111], a[176:179], v[236:239], v[108:111]
	s_mov_b32 s29, 15
	s_waitcnt vmcnt(0)
	v_max3_u32 v8, v240, v244, v248
	v_max_u32 v8, v8, v252
	v_cmp_eq_u32 vcc, -1, v8
	s_cbranch_vccnz Lrep1_77
Lret1_93:
	v_mfma_f32_16x16x32_bf16 v[64:67], a[180:183], v[240:243], v[64:67]
	v_mfma_f32_16x16x32_bf16 v[80:83], a[184:187], v[240:243], v[80:83]
	v_mfma_f32_16x16x32_bf16 v[96:99], a[188:191], v[240:243], v[96:99]
	v_mfma_f32_16x16x32_bf16 v[68:71], a[180:183], v[244:247], v[68:71]
	v_mfma_f32_16x16x32_bf16 v[84:87], a[184:187], v[244:247], v[84:87]
	v_mfma_f32_16x16x32_bf16 v[100:103], a[188:191], v[244:247], v[100:103]
	v_mfma_f32_16x16x32_bf16 v[72:75], a[180:183], v[248:251], v[72:75]
	v_mfma_f32_16x16x32_bf16 v[88:91], a[184:187], v[248:251], v[88:91]
	v_mfma_f32_16x16x32_bf16 v[104:107], a[188:191], v[248:251], v[104:107]
	v_mfma_f32_16x16x32_bf16 v[76:79], a[180:183], v[252:255], v[76:79]
	v_mfma_f32_16x16x32_bf16 v[92:95], a[184:187], v[252:255], v[92:95]
	v_mfma_f32_16x16x32_bf16 v[108:111], a[188:191], v[252:255], v[108:111]
	ds_write_b128 v28, v[68:71] offset:0
	ds_write_b128 v28, v[84:87] offset:1024
	ds_write_b128 v28, v[100:103] offset:2048
	ds_write_b128 v29, v[72:75] offset:0
	ds_write_b128 v29, v[88:91] offset:1024
	ds_write_b128 v29, v[104:107] offset:2048
	ds_write_b128 v30, v[76:79] offset:0
	ds_write_b128 v30, v[92:95] offset:1024
	ds_write_b128 v30, v[108:111] offset:2048
	s_waitcnt lgkmcnt(0)
	s_barrier
	ds_read_b128 v[128:131], v31 offset:0
	ds_read_b128 v[132:135], v31 offset:3072
	ds_read_b128 v[136:139], v31 offset:6144
	ds_read_b128 v[140:143], v31 offset:1024
	ds_read_b128 v[144:147], v31 offset:4096
	ds_read_b128 v[148:151], v31 offset:7168
	ds_read_b128 v[152:155], v31 offset:2048
	ds_read_b128 v[156:159], v31 offset:5120
	ds_read_b128 v[160:163], v31 offset:8192
	s_mov_b32 s46, 0x3dd2d3e8
	s_mov_b32 s47, 0x40135761
	s_waitcnt lgkmcnt(6)
	v_add_f32 v64, v64, v128
	v_add_f32 v65, v65, v129
	v_add_f32 v66, v66, v130
	v_add_f32 v67, v67, v131
	v_add_f32 v64, v64, v132
	v_add_f32 v65, v65, v133
	v_add_f32 v66, v66, v134
	v_add_f32 v67, v67, v135
	v_add_f32 v64, v64, v136
	v_add_f32 v65, v65, v137
	v_add_f32 v66, v66, v138
	v_add_f32 v67, v67, v139
	v_cvt_pk_bf16_f32 v40, v64, v65
	v_cvt_pk_bf16_f32 v41, v66, v67
	v_lshlrev_b32 v64, 16, v40
	v_and_b32 v65, 0xffff0000, v40
	v_lshlrev_b32 v66, 16, v41
	v_and_b32 v67, 0xffff0000, v41
	v_lshlrev_b32 v42, 16, v32
	v_and_b32 v43, 0xffff0000, v32
	v_lshlrev_b32 v44, 16, v33
	v_and_b32 v45, 0xffff0000, v33
	v_add_f32 v64, v64, v42
	v_add_f32 v65, v65, v43
	v_add_f32 v66, v66, v44
	v_add_f32 v67, v67, v45
	v_cvt_pk_bf16_f32 v40, v64, v65
	v_cvt_pk_bf16_f32 v41, v66, v67
	v_lshlrev_b32 v64, 16, v40
	v_and_b32 v65, 0xffff0000, v40
	v_lshlrev_b32 v66, 16, v41
	v_and_b32 v67, 0xffff0000, v41
	v_mul_f32 v42, v64, v64
	v_mul_f32 v43, v65, v65
	v_mul_f32 v44, v66, v66
	v_mul_f32 v45, v67, v67
	v_mov_b32 v46, s47
	v_mov_b32 v47, s47
	v_mov_b32 v48, s47
	v_mov_b32 v49, s47
	v_fmac_f32 v46, s46, v42
	v_fmac_f32 v47, s46, v43
	v_fmac_f32 v48, s46, v44
	v_fmac_f32 v49, s46, v45
	v_mul_f32 v42, v64, v46
	v_mul_f32 v43, v65, v47
	v_mul_f32 v44, v66, v48
	v_mul_f32 v45, v67, v49
	v_exp_f32 v42, -v42
	v_exp_f32 v43, -v43
	v_exp_f32 v44, -v44
	v_exp_f32 v45, -v45
	v_add_f32 v42, 1.0, v42
	v_add_f32 v43, 1.0, v43
	v_add_f32 v44, 1.0, v44
	v_add_f32 v45, 1.0, v45
	v_rcp_f32 v42, v42
	v_rcp_f32 v43, v43
	v_rcp_f32 v44, v44
	v_rcp_f32 v45, v45
	v_mul_f32 v64, v64, v42
	v_mul_f32 v65, v65, v43
	v_mul_f32 v66, v66, v44
	v_mul_f32 v67, v67, v45
	v_cvt_pk_bf16_f32 v56, v64, v65
	v_cvt_pk_bf16_f32 v57, v66, v67
	s_waitcnt lgkmcnt(3)
	v_add_f32 v80, v80, v140
	v_add_f32 v81, v81, v141
	v_add_f32 v82, v82, v142
	v_add_f32 v83, v83, v143
	v_add_f32 v80, v80, v144
	v_add_f32 v81, v81, v145
	v_add_f32 v82, v82, v146
	v_add_f32 v83, v83, v147
	v_add_f32 v80, v80, v148
	v_add_f32 v81, v81, v149
	v_add_f32 v82, v82, v150
	v_add_f32 v83, v83, v151
	v_cvt_pk_bf16_f32 v40, v80, v81
	v_cvt_pk_bf16_f32 v41, v82, v83
	v_lshlrev_b32 v80, 16, v40
	v_and_b32 v81, 0xffff0000, v40
	v_lshlrev_b32 v82, 16, v41
	v_and_b32 v83, 0xffff0000, v41
	v_lshlrev_b32 v42, 16, v34
	v_and_b32 v43, 0xffff0000, v34
	v_lshlrev_b32 v44, 16, v35
	v_and_b32 v45, 0xffff0000, v35
	v_add_f32 v80, v80, v42
	v_add_f32 v81, v81, v43
	v_add_f32 v82, v82, v44
	v_add_f32 v83, v83, v45
	v_cvt_pk_bf16_f32 v40, v80, v81
	v_cvt_pk_bf16_f32 v41, v82, v83
	v_lshlrev_b32 v80, 16, v40
	v_and_b32 v81, 0xffff0000, v40
	v_lshlrev_b32 v82, 16, v41
	v_and_b32 v83, 0xffff0000, v41
	v_mul_f32 v42, v80, v80
	v_mul_f32 v43, v81, v81
	v_mul_f32 v44, v82, v82
	v_mul_f32 v45, v83, v83
	v_mov_b32 v46, s47
	v_mov_b32 v47, s47
	v_mov_b32 v48, s47
	v_mov_b32 v49, s47
	v_fmac_f32 v46, s46, v42
	v_fmac_f32 v47, s46, v43
	v_fmac_f32 v48, s46, v44
	v_fmac_f32 v49, s46, v45
	v_mul_f32 v42, v80, v46
	v_mul_f32 v43, v81, v47
	v_mul_f32 v44, v82, v48
	v_mul_f32 v45, v83, v49
	v_exp_f32 v42, -v42
	v_exp_f32 v43, -v43
	v_exp_f32 v44, -v44
	v_exp_f32 v45, -v45
	v_add_f32 v42, 1.0, v42
	v_add_f32 v43, 1.0, v43
	v_add_f32 v44, 1.0, v44
	v_add_f32 v45, 1.0, v45
	v_rcp_f32 v42, v42
	v_rcp_f32 v43, v43
	v_rcp_f32 v44, v44
	v_rcp_f32 v45, v45
	v_mul_f32 v80, v80, v42
	v_mul_f32 v81, v81, v43
	v_mul_f32 v82, v82, v44
	v_mul_f32 v83, v83, v45
	v_cvt_pk_bf16_f32 v58, v80, v81
	v_cvt_pk_bf16_f32 v59, v82, v83
	s_cmp_ge_u32 s100, 29
	s_cbranch_scc1 L_108
	global_store_dwordx4 v38, v[56:59], s[58:59] sc1
L_108:
	s_waitcnt lgkmcnt(0)
	v_add_f32 v96, v96, v152
	v_add_f32 v97, v97, v153
	v_add_f32 v98, v98, v154
	v_add_f32 v99, v99, v155
	v_add_f32 v96, v96, v156
	v_add_f32 v97, v97, v157
	v_add_f32 v98, v98, v158
	v_add_f32 v99, v99, v159
	v_add_f32 v96, v96, v160
	v_add_f32 v97, v97, v161
	v_add_f32 v98, v98, v162
	v_add_f32 v99, v99, v163
	v_cvt_pk_bf16_f32 v40, v96, v97
	v_cvt_pk_bf16_f32 v41, v98, v99
	v_lshlrev_b32 v96, 16, v40
	v_and_b32 v97, 0xffff0000, v40
	v_lshlrev_b32 v98, 16, v41
	v_and_b32 v99, 0xffff0000, v41
	v_lshlrev_b32 v42, 16, v36
	v_and_b32 v43, 0xffff0000, v36
	v_lshlrev_b32 v44, 16, v37
	v_and_b32 v45, 0xffff0000, v37
	v_add_f32 v96, v96, v42
	v_add_f32 v97, v97, v43
	v_add_f32 v98, v98, v44
	v_add_f32 v99, v99, v45
	v_cvt_pk_bf16_f32 v40, v96, v97
	v_cvt_pk_bf16_f32 v41, v98, v99
	v_lshlrev_b32 v96, 16, v40
	v_and_b32 v97, 0xffff0000, v40
	v_lshlrev_b32 v98, 16, v41
	v_and_b32 v99, 0xffff0000, v41
	v_mul_f32 v42, v96, v96
	v_mul_f32 v43, v97, v97
	v_mul_f32 v44, v98, v98
	v_mul_f32 v45, v99, v99
	v_mov_b32 v46, s47
	v_mov_b32 v47, s47
	v_mov_b32 v48, s47
	v_mov_b32 v49, s47
	v_fmac_f32 v46, s46, v42
	v_fmac_f32 v47, s46, v43
	v_fmac_f32 v48, s46, v44
	v_fmac_f32 v49, s46, v45
	v_mul_f32 v42, v96, v46
	v_mul_f32 v43, v97, v47
	v_mul_f32 v44, v98, v48
	v_mul_f32 v45, v99, v49
	v_exp_f32 v42, -v42
	v_exp_f32 v43, -v43
	v_exp_f32 v44, -v44
	v_exp_f32 v45, -v45
	v_add_f32 v42, 1.0, v42
	v_add_f32 v43, 1.0, v43
	v_add_f32 v44, 1.0, v44
	v_add_f32 v45, 1.0, v45
	v_rcp_f32 v42, v42
	v_rcp_f32 v43, v43
	v_rcp_f32 v44, v44
	v_rcp_f32 v45, v45
	v_mul_f32 v96, v96, v42
	v_mul_f32 v97, v97, v43
	v_mul_f32 v98, v98, v44
	v_mul_f32 v99, v99, v45
	v_cvt_pk_bf16_f32 v60, v96, v97
	v_cvt_pk_bf16_f32 v61, v98, v99
	s_nop 0
	v_permlane16_swap_b32 v60, v62
	v_permlane16_swap_b32 v61, v63
	s_cmp_ge_u32 s100, 29
	s_cbranch_scc1 L_107
	s_mov_b32 exec_lo, 0x0000ffff
	s_mov_b32 exec_hi, 0x0000ffff
	global_store_dwordx4 v39, v[60:63], s[58:59] sc1
	s_mov_b64 exec, -1
L_107:
	s_bitcmp1_b32 0x1fbfdeff, s98
	s_cbranch_scc0 Lj_109
	s_mov_b32 m0, s99
	s_nop 0
	global_load_lds_dwordx4 v16, s[64:65]
	s_add_u32 m0, m0, 0x400
	s_nop 0
	global_load_lds_dwordx4 v17, s[64:65]
	s_add_u32 m0, m0, 0x400
	s_nop 0
	global_load_lds_dwordx4 v18, s[64:65]
	s_bitcmp1_b32 0x3fc0ff, s98
	s_cbranch_scc1 Lj3_110
	s_add_u32 m0, m0, 0x400
	s_nop 0
	global_load_lds_dwordx4 v19, s[64:65]
Lj3_110:
	s_add_u32 s64, s64, s101
	s_addc_u32 s65, s65, 0
	s_add_u32 s99, s99, s0
	s_add_u32 s98, s98, 1
Lj_109:
	s_bitcmp1_b32 0x1fbfdeff, s98
	s_cbranch_scc0 Lj_111
	s_mov_b32 m0, s99
	s_nop 0
	global_load_lds_dwordx4 v16, s[64:65]
	s_add_u32 m0, m0, 0x400
	s_nop 0
	global_load_lds_dwordx4 v17, s[64:65]
	s_add_u32 m0, m0, 0x400
	s_nop 0
	global_load_lds_dwordx4 v18, s[64:65]
	s_bitcmp1_b32 0x3fc0ff, s98
	s_cbranch_scc1 Lj3_112
	s_add_u32 m0, m0, 0x400
	s_nop 0
	global_load_lds_dwordx4 v19, s[64:65]
Lj3_112:
	s_add_u32 s64, s64, s101
	s_addc_u32 s65, s65, 0
	s_add_u32 s99, s99, s0
	s_add_u32 s98, s98, 1
Lj_111:
	s_bitcmp1_b32 0x1fbfdeff, s98
	s_cbranch_scc0 Lj_113
	s_mov_b32 m0, s99
	s_nop 0
	global_load_lds_dwordx4 v16, s[64:65]
	s_add_u32 m0, m0, 0x400
	s_nop 0
	global_load_lds_dwordx4 v17, s[64:65]
	s_add_u32 m0, m0, 0x400
	s_nop 0
	global_load_lds_dwordx4 v18, s[64:65]
	s_bitcmp1_b32 0x3fc0ff, s98
	s_cbranch_scc1 Lj3_114
	s_add_u32 m0, m0, 0x400
	s_nop 0
	global_load_lds_dwordx4 v19, s[64:65]
Lj3_114:
	s_add_u32 s64, s64, s101
	s_addc_u32 s65, s65, 0
	s_add_u32 s99, s99, s0
	s_add_u32 s98, s98, 1
Lj_113:
	s_bitcmp1_b32 0x1fbfdeff, s98
	s_cbranch_scc0 Lj_115
	s_mov_b32 m0, s99
	s_nop 0
	global_load_lds_dwordx4 v16, s[64:65]
	s_add_u32 m0, m0, 0x400
	s_nop 0
	global_load_lds_dwordx4 v17, s[64:65]
	s_add_u32 m0, m0, 0x400
	s_nop 0
	global_load_lds_dwordx4 v18, s[64:65]
	s_bitcmp1_b32 0x3fc0ff, s98
	s_cbranch_scc1 Lj3_116
	s_add_u32 m0, m0, 0x400
	s_nop 0
	global_load_lds_dwordx4 v19, s[64:65]
Lj3_116:
	s_add_u32 s64, s64, s101
	s_addc_u32 s65, s65, 0
	s_add_u32 s99, s99, s0
	s_add_u32 s98, s98, 1
Lj_115:
	s_bitcmp1_b32 0x1fbfdeff, s98
	s_cbranch_scc0 Lj_117
	s_mov_b32 m0, s99
	s_nop 0
	global_load_lds_dwordx4 v16, s[64:65]
	s_add_u32 m0, m0, 0x400
	s_nop 0
	global_load_lds_dwordx4 v17, s[64:65]
	s_add_u32 m0, m0, 0x400
	s_nop 0
	global_load_lds_dwordx4 v18, s[64:65]
	s_bitcmp1_b32 0x3fc0ff, s98
	s_cbranch_scc1 Lj3_118
	s_add_u32 m0, m0, 0x400
	s_nop 0
	global_load_lds_dwordx4 v19, s[64:65]
Lj3_118:
	s_add_u32 s64, s64, s101
	s_addc_u32 s65, s65, 0
	s_add_u32 s99, s99, s0
	s_add_u32 s98, s98, 1
Lj_117:
	s_bitcmp1_b32 0x1fbfdeff, s98
	s_cbranch_scc0 Lj_119
	s_mov_b32 m0, s99
	s_nop 0
	global_load_lds_dwordx4 v16, s[64:65]
	s_add_u32 m0, m0, 0x400
	s_nop 0
	global_load_lds_dwordx4 v17, s[64:65]
	s_add_u32 m0, m0, 0x400
	s_nop 0
	global_load_lds_dwordx4 v18, s[64:65]
	s_bitcmp1_b32 0x3fc0ff, s98
	s_cbranch_scc1 Lj3_120
	s_add_u32 m0, m0, 0x400
	s_nop 0
	global_load_lds_dwordx4 v19, s[64:65]
Lj3_120:
	s_add_u32 s64, s64, s101
	s_addc_u32 s65, s65, 0
	s_add_u32 s99, s99, s0
	s_add_u32 s98, s98, 1
Lj_119:
	s_cmp_eq_u32 s3, 3
	s_cbranch_scc1 L_121
	s_add_u32 s62, s68, 1310720
	s_addc_u32 s63, s69, 0
	s_add_u32 m0, s67, 0
	s_nop 0
	global_load_lds_dwordx4 v10, s[62:63]
L_121:
	s_cmp_eq_u32 s3, 3
	s_cbranch_scc1 L_122
	s_add_u32 s62, s68, 1343488
	s_addc_u32 s63, s69, 0
	s_add_u32 m0, s67, 1024
	s_nop 0
	global_load_lds_dwordx4 v11, s[62:63]
L_122:
	s_cmp_eq_u32 s3, 3
	s_cbranch_scc1 L_123
	s_add_u32 s62, s68, 1376256
	s_addc_u32 s63, s69, 0
	s_add_u32 m0, s67, 2048
	s_nop 0
	global_load_lds_dwordx4 v10, s[62:63]
L_123:
	s_cmp_eq_u32 s3, 3
	s_cbranch_scc1 L_124
	s_add_u32 s62, s68, 1409024
	s_addc_u32 s63, s69, 0
	s_add_u32 m0, s67, 3072
	s_nop 0
	global_load_lds_dwordx4 v11, s[62:63]
L_124:
	v_lshlrev_b32 v4, 10, v2
	v_lshl_add_u32 v25, v3, 4, v4
	s_lshl_b32 s36, s100, 16
	s_lshl_b32 s37, s3, 14
	s_add_u32 s36, s36, s37
	s_lshl_b32 s37, s97, 7
	s_add_u32 s36, s36, s37
	s_add_u32 s58, s24, s36
	s_addc_u32 s59, s25, 0
	s_add_u32 s58, s58, 7340032
	s_addc_u32 s59, s59, 0
	s_add_u32 s60, s20, s36
	s_addc_u32 s61, s21, 0
	s_lshl_b32 s36, s100, 7
	s_lshl_b32 s37, s3, 5
	s_add_u32 s36, s36, s37
	v_lshlrev_b32 v4, 1, v2
	s_add_u32 s34, s18, s36
	s_addc_u32 s35, s19, 0
	global_load_ushort v26, v4, s[34:35]
	v_lshlrev_b32 v4, 4, v2
	v_lshl_add_u32 v4, v3, 13, v4
	s_lshl_b32 s36, s97, 10
	v_add_u32 v24, s36, v4
	s_mul_i32 s36, s3, 360448
	s_add_u32 s56, s24, s36
	s_addc_u32 s57, s25, 0
	s_add_u32 s56, s56, 11534336
	s_addc_u32 s57, s57, 0
	v_lshlrev_b32 v8, 4, v1
	v_add_u32 v28, s66, v8
	s_xor_b32 s36, s3, 1
	s_mul_i32 s36, s36, 24576
	s_add_u32 s36, s36, 0
	v_add_u32 v29, s36, v8
	s_xor_b32 s36, s3, 2
	s_mul_i32 s36, s36, 24576
	s_add_u32 s36, s36, 4096
	v_add_u32 v30, s36, v8
	s_xor_b32 s36, s3, 3
	s_mul_i32 s36, s36, 24576
	s_add_u32 s36, s36, 8192
	v_add_u32 v31, s36, v8
	s_sub_u32 s36, s67, s66
	v_add_u32 v4, s36, v12
	v_add_u32 v5, s36, v13
	v_add_u32 v6, s36, v14
	v_add_u32 v7, s36, v15
	s_mov_b32 s28, 0
	s_cmp_ge_u32 s98, 29
	s_cbranch_scc1 Ljd_138
Ljf_137:
	s_bitcmp1_b32 0x1fbfdeff, s98
	s_cbranch_scc0 Lj_139
	s_mov_b32 m0, s99
	s_nop 0
	global_load_lds_dwordx4 v16, s[64:65]
	s_add_u32 m0, m0, 0x400
	s_nop 0
	global_load_lds_dwordx4 v17, s[64:65]
	s_add_u32 m0, m0, 0x400
	s_nop 0
	global_load_lds_dwordx4 v18, s[64:65]
	s_bitcmp1_b32 0x3fc0ff, s98
	s_cbranch_scc1 Lj3_140
	s_add_u32 m0, m0, 0x400
	s_nop 0
	global_load_lds_dwordx4 v19, s[64:65]
Lj3_140:
	s_add_u32 s64, s64, s101
	s_addc_u32 s65, s65, 0
	s_add_u32 s99, s99, s0
	s_add_u32 s98, s98, 1
Lj_139:
	s_cmp_lt_u32 s98, 29
	s_cbranch_scc1 Ljf_137
	s_waitcnt vmcnt(0)
Ljd_138:
	s_add_u32 s40, s56, 0
	s_addc_u32 s41, s57, 0
	global_load_dwordx4 v[128:131], v24, s[40:41] offset:0 sc1
	global_load_dwordx4 v[132:135], v24, s[40:41] offset:256 sc1
	global_load_dwordx4 v[136:139], v24, s[40:41] offset:512 sc1
	global_load_dwordx4 v[140:143], v24, s[40:41] offset:768 sc1
	s_add_u32 s42, s56, 32768
	s_addc_u32 s43, s57, 0
	global_load_dwordx4 v[144:147], v24, s[42:43] offset:0 sc1
	global_load_dwordx4 v[148:151], v24, s[42:43] offset:256 sc1
	global_load_dwordx4 v[152:155], v24, s[42:43] offset:512 sc1
	global_load_dwordx4 v[156:159], v24, s[42:43] offset:768 sc1
	s_add_u32 s44, s56, 65536
	s_addc_u32 s45, s57, 0
	global_load_dwordx4 v[160:163], v24, s[44:45] offset:0 sc1
	global_load_dwordx4 v[164:167], v24, s[44:45] offset:256 sc1
	global_load_dwordx4 v[168:171], v24, s[44:45] offset:512 sc1
	global_load_dwordx4 v[172:175], v24, s[44:45] offset:768 sc1
	s_add_u32 s46, s56, 98304
	s_addc_u32 s47, s57, 0
	global_load_dwordx4 v[176:179], v24, s[46:47] offset:0 sc1
	global_load_dwordx4 v[180:183], v24, s[46:47] offset:256 sc1
	global_load_dwordx4 v[184:187], v24, s[46:47] offset:512 sc1
	global_load_dwordx4 v[188:191], v24, s[46:47] offset:768 sc1
	s_waitcnt vmcnt(12)
	v_max3_u32 v8, v128, v132, v136
	v_max_u32 v8, v8, v140
	v_cmp_eq_u32 vcc, -1, v8
	s_cbranch_vccnz Lfs_143
Lfd_142:
	v_lshlrev_b32 v26, 16, v26
	global_load_dwordx4 v[16:19], v25, s[58:59] sc1
	global_load_dwordx4 v[20:23], v25, s[58:59] offset:64 sc1
	s_mov_b32 s29, 0
	s_waitcnt vmcnt(14)
	v_max3_u32 v8, v128, v132, v136
	v_max_u32 v8, v8, v140
	v_cmp_eq_u32 vcc, -1, v8
	s_cbranch_vccnz Lrep2_125
Lret2_126:
	s_add_u32 s48, s56, 131072
	s_addc_u32 s49, s57, 0
	v_mfma_f32_16x16x32_bf16 v[64:67], v[128:131], a[192:195], 0
	global_load_dwordx4 v[192:195], v24, s[48:49] offset:0 sc1
	v_mfma_f32_16x16x32_bf16 v[68:71], v[128:131], a[196:199], 0
	v_mfma_f32_16x16x32_bf16 v[72:75], v[128:131], a[200:203], 0
	v_mfma_f32_16x16x32_bf16 v[76:79], v[128:131], a[204:207], 0
	v_mfma_f32_16x16x32_bf16 v[80:83], v[132:135], a[192:195], 0
	global_load_dwordx4 v[196:199], v24, s[48:49] offset:256 sc1
	v_mfma_f32_16x16x32_bf16 v[84:87], v[132:135], a[196:199], 0
	v_mfma_f32_16x16x32_bf16 v[88:91], v[132:135], a[200:203], 0
	v_mfma_f32_16x16x32_bf16 v[92:95], v[132:135], a[204:207], 0
	v_mfma_f32_16x16x32_bf16 v[96:99], v[136:139], a[192:195], 0
	global_load_dwordx4 v[200:203], v24, s[48:49] offset:512 sc1
	v_mfma_f32_16x16x32_bf16 v[100:103], v[136:139], a[196:199], 0
	v_mfma_f32_16x16x32_bf16 v[104:107], v[136:139], a[200:203], 0
	v_mfma_f32_16x16x32_bf16 v[108:111], v[136:139], a[204:207], 0
	v_mfma_f32_16x16x32_bf16 v[112:115], v[140:143], a[192:195], 0
	global_load_dwordx4 v[204:207], v24, s[48:49] offset:768 sc1
	v_mfma_f32_16x16x32_bf16 v[116:119], v[140:143], a[196:199], 0
	v_mfma_f32_16x16x32_bf16 v[120:123], v[140:143], a[200:203], 0
	v_mfma_f32_16x16x32_bf16 v[124:127], v[140:143], a[204:207], 0
	s_mov_b32 s29, 1
	s_waitcnt vmcnt(14)
	v_max3_u32 v8, v144, v148, v152
	v_max_u32 v8, v8, v156
	v_cmp_eq_u32 vcc, -1, v8
	s_cbranch_vccnz Lrep2_125
Lret2_127:
	s_add_u32 s50, s56, 163840
	s_addc_u32 s51, s57, 0
	v_mfma_f32_16x16x32_bf16 v[64:67], v[144:147], a[208:211], v[64:67]
	global_load_dwordx4 v[208:211], v24, s[50:51] offset:0 sc1
	v_mfma_f32_16x16x32_bf16 v[68:71], v[144:147], a[212:215], v[68:71]
	v_mfma_f32_16x16x32_bf16 v[72:75], v[144:147], a[216:219], v[72:75]
	v_mfma_f32_16x16x32_bf16 v[76:79], v[144:147], a[220:223], v[76:79]
	v_mfma_f32_16x16x32_bf16 v[80:83], v[148:151], a[208:211], v[80:83]
	global_load_dwordx4 v[212:215], v24, s[50:51] offset:256 sc1
	v_mfma_f32_16x16x32_bf16 v[84:87], v[148:151], a[212:215], v[84:87]
	v_mfma_f32_16x16x32_bf16 v[88:91], v[148:151], a[216:219], v[88:91]
	v_mfma_f32_16x16x32_bf16 v[92:95], v[148:151], a[220:223], v[92:95]
	v_mfma_f32_16x16x32_bf16 v[96:99], v[152:155], a[208:211], v[96:99]
	global_load_dwordx4 v[216:219], v24, s[50:51] offset:512 sc1
	v_mfma_f32_16x16x32_bf16 v[100:103], v[152:155], a[212:215], v[100:103]
	v_mfma_f32_16x16x32_bf16 v[104:107], v[152:155], a[216:219], v[104:107]
	v_mfma_f32_16x16x32_bf16 v[108:111], v[152:155], a[220:223], v[108:111]
	v_mfma_f32_16x16x32_bf16 v[112:115], v[156:159], a[208:211], v[112:115]
	global_load_dwordx4 v[220:223], v24, s[50:51] offset:768 sc1
	v_mfma_f32_16x16x32_bf16 v[116:119], v[156:159], a[212:215], v[116:119]
	v_mfma_f32_16x16x32_bf16 v[120:123], v[156:159], a[216:219], v[120:123]
	v_mfma_f32_16x16x32_bf16 v[124:127], v[156:159], a[220:223], v[124:127]
	s_mov_b32 s29, 2
	s_waitcnt vmcnt(14)
	v_max3_u32 v8, v160, v164, v168
	v_max_u32 v8, v8, v172
	v_cmp_eq_u32 vcc, -1, v8
	s_cbranch_vccnz Lrep2_125
Lret2_128:
	s_add_u32 s52, s56, 196608
	s_addc_u32 s53, s57, 0
	v_mfma_f32_16x16x32_bf16 v[64:67], v[160:163], a[224:227], v[64:67]
	global_load_dwordx4 v[224:227], v24, s[52:53] offset:0 sc1
	v_mfma_f32_16x16x32_bf16 v[68:71], v[160:163], a[228:231], v[68:71]
	v_mfma_f32_16x16x32_bf16 v[72:75], v[160:163], a[232:235], v[72:75]
	v_mfma_f32_16x16x32_bf16 v[76:79], v[160:163], a[236:239], v[76:79]
	v_mfma_f32_16x16x32_bf16 v[80:83], v[164:167], a[224:227], v[80:83]
	global_load_dwordx4 v[228:231], v24, s[52:53] offset:256 sc1
	v_mfma_f32_16x16x32_bf16 v[84:87], v[164:167], a[228:231], v[84:87]
	v_mfma_f32_16x16x32_bf16 v[88:91], v[164:167], a[232:235], v[88:91]
	v_mfma_f32_16x16x32_bf16 v[92:95], v[164:167], a[236:239], v[92:95]
	v_mfma_f32_16x16x32_bf16 v[96:99], v[168:171], a[224:227], v[96:99]
	global_load_dwordx4 v[232:235], v24, s[52:53] offset:512 sc1
	v_mfma_f32_16x16x32_bf16 v[100:103], v[168:171], a[228:231], v[100:103]
	v_mfma_f32_16x16x32_bf16 v[104:107], v[168:171], a[232:235], v[104:107]
	v_mfma_f32_16x16x32_bf16 v[108:111], v[168:171], a[236:239], v[108:111]
	v_mfma_f32_16x16x32_bf16 v[112:115], v[172:175], a[224:227], v[112:115]
	global_load_dwordx4 v[236:239], v24, s[52:53] offset:768 sc1
	v_mfma_f32_16x16x32_bf16 v[116:119], v[172:175], a[228:231], v[116:119]
	v_mfma_f32_16x16x32_bf16 v[120:123], v[172:175], a[232:235], v[120:123]
	v_mfma_f32_16x16x32_bf16 v[124:127], v[172:175], a[236:239], v[124:127]
	s_mov_b32 s29, 3
	ds_read_b64_tr_b16 v[32:33], v12 offset:0
	ds_read_b64_tr_b16 v[34:35], v12 offset:512
	ds_read_b64_tr_b16 v[36:37], v13 offset:0
	ds_read_b64_tr_b16 v[38:39], v13 offset:512
	ds_read_b64_tr_b16 v[40:41], v14 offset:0
	ds_read_b64_tr_b16 v[42:43], v14 offset:512
	ds_read_b64_tr_b16 v[44:45], v15 offset:0
	ds_read_b64_tr_b16 v[46:47], v15 offset:512
	s_waitcnt vmcnt(14)
	v_max3_u32 v8, v176, v180, v184
	v_max_u32 v8, v8, v188
	v_cmp_eq_u32 vcc, -1, v8
	s_cbranch_vccnz Lrep2_125
Lret2_129:
	s_add_u32 s54, s56, 229376
	s_addc_u32 s55, s57, 0
	v_mfma_f32_16x16x32_bf16 v[64:67], v[176:179], a[240:243], v[64:67]
	global_load_dwordx4 v[240:243], v24, s[54:55] offset:0 sc1
	v_mfma_f32_16x16x32_bf16 v[68:71], v[176:179], a[244:247], v[68:71]
	v_mfma_f32_16x16x32_bf16 v[72:75], v[176:179], a[248:251], v[72:75]
	v_mfma_f32_16x16x32_bf16 v[76:79], v[176:179], a[252:255], v[76:79]
	v_mfma_f32_16x16x32_bf16 v[80:83], v[180:183], a[240:243], v[80:83]
	global_load_dwordx4 v[244:247], v24, s[54:55] offset:256 sc1
	v_mfma_f32_16x16x32_bf16 v[84:87], v[180:183], a[244:247], v[84:87]
	v_mfma_f32_16x16x32_bf16 v[88:91], v[180:183], a[248:251], v[88:91]
	v_mfma_f32_16x16x32_bf16 v[92:95], v[180:183], a[252:255], v[92:95]
	v_mfma_f32_16x16x32_bf16 v[96:99], v[184:187], a[240:243], v[96:99]
	global_load_dwordx4 v[248:251], v24, s[54:55] offset:512 sc1
	v_mfma_f32_16x16x32_bf16 v[100:103], v[184:187], a[244:247], v[100:103]
	v_mfma_f32_16x16x32_bf16 v[104:107], v[184:187], a[248:251], v[104:107]
	v_mfma_f32_16x16x32_bf16 v[108:111], v[184:187], a[252:255], v[108:111]
	v_mfma_f32_16x16x32_bf16 v[112:115], v[188:191], a[240:243], v[112:115]
	global_load_dwordx4 v[252:255], v24, s[54:55] offset:768 sc1
	v_mfma_f32_16x16x32_bf16 v[116:119], v[188:191], a[244:247], v[116:119]
	v_mfma_f32_16x16x32_bf16 v[120:123], v[188:191], a[248:251], v[120:123]
	v_mfma_f32_16x16x32_bf16 v[124:127], v[188:191], a[252:255], v[124:127]
	s_mov_b32 s29, 4
	ds_read_b64_tr_b16 v[48:49], v12 offset:4096
	ds_read_b64_tr_b16 v[50:51], v12 offset:4608
	ds_read_b64_tr_b16 v[52:53], v13 offset:4096
	ds_read_b64_tr_b16 v[54:55], v13 offset:4608
	ds_read_b64_tr_b16 v[56:57], v14 offset:4096
	ds_read_b64_tr_b16 v[58:59], v14 offset:4608
	ds_read_b64_tr_b16 v[60:61], v15 offset:4096
	ds_read_b64_tr_b16 v[62:63], v15 offset:4608
	s_waitcnt vmcnt(12)
	v_max3_u32 v8, v192, v196, v200
	v_max_u32 v8, v8, v204
	v_cmp_eq_u32 vcc, -1, v8
	s_cbranch_vccnz Lrep2_125
Lret2_130:
	s_waitcnt lgkmcnt(8)
	s_add_u32 s40, s56, 262144
	s_addc_u32 s41, s57, 0
	v_mfma_f32_16x16x32_bf16 v[64:67], v[192:195], v[32:35], v[64:67]
	global_load_dwordx4 v[128:131], v24, s[40:41] offset:0 sc1
	v_mfma_f32_16x16x32_bf16 v[68:71], v[192:195], v[36:39], v[68:71]
	v_mfma_f32_16x16x32_bf16 v[72:75], v[192:195], v[40:43], v[72:75]
	v_mfma_f32_16x16x32_bf16 v[76:79], v[192:195], v[44:47], v[76:79]
	v_mfma_f32_16x16x32_bf16 v[80:83], v[196:199], v[32:35], v[80:83]
	global_load_dwordx4 v[132:135], v24, s[40:41] offset:256 sc1
	v_mfma_f32_16x16x32_bf16 v[84:87], v[196:199], v[36:39], v[84:87]
	v_mfma_f32_16x16x32_bf16 v[88:91], v[196:199], v[40:43], v[88:91]
	v_mfma_f32_16x16x32_bf16 v[92:95], v[196:199], v[44:47], v[92:95]
	v_mfma_f32_16x16x32_bf16 v[96:99], v[200:203], v[32:35], v[96:99]
	global_load_dwordx4 v[136:139], v24, s[40:41] offset:512 sc1
	v_mfma_f32_16x16x32_bf16 v[100:103], v[200:203], v[36:39], v[100:103]
	v_mfma_f32_16x16x32_bf16 v[104:107], v[200:203], v[40:43], v[104:107]
	v_mfma_f32_16x16x32_bf16 v[108:111], v[200:203], v[44:47], v[108:111]
	v_mfma_f32_16x16x32_bf16 v[112:115], v[204:207], v[32:35], v[112:115]
	global_load_dwordx4 v[140:143], v24, s[40:41] offset:768 sc1
	v_mfma_f32_16x16x32_bf16 v[116:119], v[204:207], v[36:39], v[116:119]
	v_mfma_f32_16x16x32_bf16 v[120:123], v[204:207], v[40:43], v[120:123]
	v_mfma_f32_16x16x32_bf16 v[124:127], v[204:207], v[44:47], v[124:127]
	s_mov_b32 s29, 5
	ds_read_b64_tr_b16 v[32:33], v12 offset:8192
	ds_read_b64_tr_b16 v[34:35], v12 offset:8704
	ds_read_b64_tr_b16 v[36:37], v13 offset:8192
	ds_read_b64_tr_b16 v[38:39], v13 offset:8704
	ds_read_b64_tr_b16 v[40:41], v14 offset:8192
	ds_read_b64_tr_b16 v[42:43], v14 offset:8704
	ds_read_b64_tr_b16 v[44:45], v15 offset:8192
	ds_read_b64_tr_b16 v[46:47], v15 offset:8704
	s_waitcnt vmcnt(12)
	v_max3_u32 v8, v208, v212, v216
	v_max_u32 v8, v8, v220
	v_cmp_eq_u32 vcc, -1, v8
	s_cbranch_vccnz Lrep2_125
Lret2_131:
	s_waitcnt lgkmcnt(8)
	s_add_u32 s42, s56, 294912
	s_addc_u32 s43, s57, 0
	v_mfma_f32_16x16x32_bf16 v[64:67], v[208:211], v[48:51], v[64:67]
	global_load_dwordx4 v[144:147], v24, s[42:43] offset:0 sc1
	v_mfma_f32_16x16x32_bf16 v[68:71], v[208:211], v[52:55], v[68:71]
	v_mfma_f32_16x16x32_bf16 v[72:75], v[208:211], v[56:59], v[72:75]
	v_mfma_f32_16x16x32_bf16 v[76:79], v[208:211], v[60:63], v[76:79]
	v_mfma_f32_16x16x32_bf16 v[80:83], v[212:215], v[48:51], v[80:83]
	global_load_dwordx4 v[148:151], v24, s[42:43] offset:256 sc1
	v_mfma_f32_16x16x32_bf16 v[84:87], v[212:215], v[52:55], v[84:87]
	v_mfma_f32_16x16x32_bf16 v[88:91], v[212:215], v[56:59], v[88:91]
	v_mfma_f32_16x16x32_bf16 v[92:95], v[212:215], v[60:63], v[92:95]
	v_mfma_f32_16x16x32_bf16 v[96:99], v[216:219], v[48:51], v[96:99]
	global_load_dwordx4 v[152:155], v24, s[42:43] offset:512 sc1
	v_mfma_f32_16x16x32_bf16 v[100:103], v[216:219], v[52:55], v[100:103]
	v_mfma_f32_16x16x32_bf16 v[104:107], v[216:219], v[56:59], v[104:107]
	v_mfma_f32_16x16x32_bf16 v[108:111], v[216:219], v[60:63], v[108:111]
	v_mfma_f32_16x16x32_bf16 v[112:115], v[220:223], v[48:51], v[112:115]
	global_load_dwordx4 v[156:159], v24, s[42:43] offset:768 sc1
	v_mfma_f32_16x16x32_bf16 v[116:119], v[220:223], v[52:55], v[116:119]
	v_mfma_f32_16x16x32_bf16 v[120:123], v[220:223], v[56:59], v[120:123]
	v_mfma_f32_16x16x32_bf16 v[124:127], v[220:223], v[60:63], v[124:127]
	s_mov_b32 s29, 6
	ds_read_b64_tr_b16 v[48:49], v12 offset:12288
	ds_read_b64_tr_b16 v[50:51], v12 offset:12800
	ds_read_b64_tr_b16 v[52:53], v13 offset:12288
	ds_read_b64_tr_b16 v[54:55], v13 offset:12800
	ds_read_b64_tr_b16 v[56:57], v14 offset:12288
	ds_read_b64_tr_b16 v[58:59], v14 offset:12800
	ds_read_b64_tr_b16 v[60:61], v15 offset:12288
	ds_read_b64_tr_b16 v[62:63], v15 offset:12800
	s_waitcnt vmcnt(12)
	v_max3_u32 v8, v224, v228, v232
	v_max_u32 v8, v8, v236
	v_cmp_eq_u32 vcc, -1, v8
	s_cbranch_vccnz Lrep2_125
Lret2_132:
	s_waitcnt lgkmcnt(8)
	v_mfma_f32_16x16x32_bf16 v[64:67], v[224:227], v[32:35], v[64:67]
	v_mfma_f32_16x16x32_bf16 v[68:71], v[224:227], v[36:39], v[68:71]
	v_mfma_f32_16x16x32_bf16 v[72:75], v[224:227], v[40:43], v[72:75]
	v_mfma_f32_16x16x32_bf16 v[76:79], v[224:227], v[44:47], v[76:79]
	v_mfma_f32_16x16x32_bf16 v[80:83], v[228:231], v[32:35], v[80:83]
	v_mfma_f32_16x16x32_bf16 v[84:87], v[228:231], v[36:39], v[84:87]
	v_mfma_f32_16x16x32_bf16 v[88:91], v[228:231], v[40:43], v[88:91]
	v_mfma_f32_16x16x32_bf16 v[92:95], v[228:231], v[44:47], v[92:95]
	v_mfma_f32_16x16x32_bf16 v[96:99], v[232:235], v[32:35], v[96:99]
	v_mfma_f32_16x16x32_bf16 v[100:103], v[232:235], v[36:39], v[100:103]
	v_mfma_f32_16x16x32_bf16 v[104:107], v[232:235], v[40:43], v[104:107]
	v_mfma_f32_16x16x32_bf16 v[108:111], v[232:235], v[44:47], v[108:111]
	v_mfma_f32_16x16x32_bf16 v[112:115], v[236:239], v[32:35], v[112:115]
	v_mfma_f32_16x16x32_bf16 v[116:119], v[236:239], v[36:39], v[116:119]
	v_mfma_f32_16x16x32_bf16 v[120:123], v[236:239], v[40:43], v[120:123]
	v_mfma_f32_16x16x32_bf16 v[124:127], v[236:239], v[44:47], v[124:127]
	s_cmp_eq_u32 s3, 3
	s_cbranch_scc1 L_146
	s_add_u32 s44, s56, 327680
	s_addc_u32 s45, s57, 0
	global_load_dwordx4 v[160:163], v24, s[44:45] offset:0 sc1
	global_load_dwordx4 v[164:167], v24, s[44:45] offset:256 sc1
	global_load_dwordx4 v[168:171], v24, s[44:45] offset:512 sc1
	global_load_dwordx4 v[172:175], v24, s[44:45] offset:768 sc1
L_146:
	s_mov_b32 s29, 7
	ds_read_b64_tr_b16 v[32:33], v12 offset:16384
	ds_read_b64_tr_b16 v[34:35], v12 offset:16896
	ds_read_b64_tr_b16 v[36:37], v13 offset:16384
	ds_read_b64_tr_b16 v[38:39], v13 offset:16896
	ds_read_b64_tr_b16 v[40:41], v14 offset:16384
	ds_read_b64_tr_b16 v[42:43], v14 offset:16896
	ds_read_b64_tr_b16 v[44:45], v15 offset:16384
	ds_read_b64_tr_b16 v[46:47], v15 offset:16896
	s_waitcnt vmcnt(8)
	v_max3_u32 v8, v240, v244, v248
	v_max_u32 v8, v8, v252
	v_cmp_eq_u32 vcc, -1, v8
	s_cbranch_vccnz Lrep2_125
Lret2_133:
	s_waitcnt lgkmcnt(8)
	v_mfma_f32_16x16x32_bf16 v[64:67], v[240:243], v[48:51], v[64:67]
	v_mfma_f32_16x16x32_bf16 v[68:71], v[240:243], v[52:55], v[68:71]
	v_mfma_f32_16x16x32_bf16 v[72:75], v[240:243], v[56:59], v[72:75]
	v_mfma_f32_16x16x32_bf16 v[76:79], v[240:243], v[60:63], v[76:79]
	v_mfma_f32_16x16x32_bf16 v[80:83], v[244:247], v[48:51], v[80:83]
	v_mfma_f32_16x16x32_bf16 v[84:87], v[244:247], v[52:55], v[84:87]
	v_mfma_f32_16x16x32_bf16 v[88:91], v[244:247], v[56:59], v[88:91]
	v_mfma_f32_16x16x32_bf16 v[92:95], v[244:247], v[60:63], v[92:95]
	v_mfma_f32_16x16x32_bf16 v[96:99], v[248:251], v[48:51], v[96:99]
	v_mfma_f32_16x16x32_bf16 v[100:103], v[248:251], v[52:55], v[100:103]
	v_mfma_f32_16x16x32_bf16 v[104:107], v[248:251], v[56:59], v[104:107]
	v_mfma_f32_16x16x32_bf16 v[108:111], v[248:251], v[60:63], v[108:111]
	v_mfma_f32_16x16x32_bf16 v[112:115], v[252:255], v[48:51], v[112:115]
	v_mfma_f32_16x16x32_bf16 v[116:119], v[252:255], v[52:55], v[116:119]
	v_mfma_f32_16x16x32_bf16 v[120:123], v[252:255], v[56:59], v[120:123]
	v_mfma_f32_16x16x32_bf16 v[124:127], v[252:255], v[60:63], v[124:127]
	s_mov_b32 s29, 8
	ds_read_b64_tr_b16 v[48:49], v12 offset:20480
	ds_read_b64_tr_b16 v[50:51], v12 offset:20992
	ds_read_b64_tr_b16 v[52:53], v13 offset:20480
	ds_read_b64_tr_b16 v[54:55], v13 offset:20992
	ds_read_b64_tr_b16 v[56:57], v14 offset:20480
	ds_read_b64_tr_b16 v[58:59], v14 offset:20992
	ds_read_b64_tr_b16 v[60:61], v15 offset:20480
	ds_read_b64_tr_b16 v[62:63], v15 offset:20992
	s_waitcnt vmcnt(4)
	v_max3_u32 v8, v128, v132, v136
	v_max_u32 v8, v8, v140
	v_cmp_eq_u32 vcc, -1, v8
	s_cbranch_vccnz Lrep2_125
Lret2_134:
	s_waitcnt lgkmcnt(8)
	v_mfma_f32_16x16x32_bf16 v[64:67], v[128:131], v[32:35], v[64:67]
	v_mfma_f32_16x16x32_bf16 v[68:71], v[128:131], v[36:39], v[68:71]
	v_mfma_f32_16x16x32_bf16 v[72:75], v[128:131], v[40:43], v[72:75]
	v_mfma_f32_16x16x32_bf16 v[76:79], v[128:131], v[44:47], v[76:79]
	v_mfma_f32_16x16x32_bf16 v[80:83], v[132:135], v[32:35], v[80:83]
	v_mfma_f32_16x16x32_bf16 v[84:87], v[132:135], v[36:39], v[84:87]
	v_mfma_f32_16x16x32_bf16 v[88:91], v[132:135], v[40:43], v[88:91]
	v_mfma_f32_16x16x32_bf16 v[92:95], v[132:135], v[44:47], v[92:95]
	v_mfma_f32_16x16x32_bf16 v[96:99], v[136:139], v[32:35], v[96:99]
	v_mfma_f32_16x16x32_bf16 v[100:103], v[136:139], v[36:39], v[100:103]
	v_mfma_f32_16x16x32_bf16 v[104:107], v[136:139], v[40:43], v[104:107]
	v_mfma_f32_16x16x32_bf16 v[108:111], v[136:139], v[44:47], v[108:111]
	v_mfma_f32_16x16x32_bf16 v[112:115], v[140:143], v[32:35], v[112:115]
	v_mfma_f32_16x16x32_bf16 v[116:119], v[140:143], v[36:39], v[116:119]
	v_mfma_f32_16x16x32_bf16 v[120:123], v[140:143], v[40:43], v[120:123]
	v_mfma_f32_16x16x32_bf16 v[124:127], v[140:143], v[44:47], v[124:127]
	s_mov_b32 s29, 9
	ds_read_b64_tr_b16 v[32:33], v4 offset:0
	ds_read_b64_tr_b16 v[34:35], v4 offset:512
	ds_read_b64_tr_b16 v[36:37], v5 offset:0
	ds_read_b64_tr_b16 v[38:39], v5 offset:512
	ds_read_b64_tr_b16 v[40:41], v6 offset:0
	ds_read_b64_tr_b16 v[42:43], v6 offset:512
	ds_read_b64_tr_b16 v[44:45], v7 offset:0
	ds_read_b64_tr_b16 v[46:47], v7 offset:512
	s_waitcnt vmcnt(0)
	v_max3_u32 v8, v144, v148, v152
	v_max_u32 v8, v8, v156
	v_cmp_eq_u32 vcc, -1, v8
	s_cbranch_vccnz Lrep2_125
Lret2_135:
	s_waitcnt lgkmcnt(8)
	v_mfma_f32_16x16x32_bf16 v[64:67], v[144:147], v[48:51], v[64:67]
	v_mfma_f32_16x16x32_bf16 v[68:71], v[144:147], v[52:55], v[68:71]
	v_mfma_f32_16x16x32_bf16 v[72:75], v[144:147], v[56:59], v[72:75]
	v_mfma_f32_16x16x32_bf16 v[76:79], v[144:147], v[60:63], v[76:79]
	v_mfma_f32_16x16x32_bf16 v[80:83], v[148:151], v[48:51], v[80:83]
	v_mfma_f32_16x16x32_bf16 v[84:87], v[148:151], v[52:55], v[84:87]
	v_mfma_f32_16x16x32_bf16 v[88:91], v[148:151], v[56:59], v[88:91]
	v_mfma_f32_16x16x32_bf16 v[92:95], v[148:151], v[60:63], v[92:95]
	v_mfma_f32_16x16x32_bf16 v[96:99], v[152:155], v[48:51], v[96:99]
	v_mfma_f32_16x16x32_bf16 v[100:103], v[152:155], v[52:55], v[100:103]
	v_mfma_f32_16x16x32_bf16 v[104:107], v[152:155], v[56:59], v[104:107]
	v_mfma_f32_16x16x32_bf16 v[108:111], v[152:155], v[60:63], v[108:111]
	v_mfma_f32_16x16x32_bf16 v[112:115], v[156:159], v[48:51], v[112:115]
	v_mfma_f32_16x16x32_bf16 v[116:119], v[156:159], v[52:55], v[116:119]
	v_mfma_f32_16x16x32_bf16 v[120:123], v[156:159], v[56:59], v[120:123]
	v_mfma_f32_16x16x32_bf16 v[124:127], v[156:159], v[60:63], v[124:127]
	s_cmp_eq_u32 s3, 3
	s_cbranch_scc1 L_145
	s_mov_b32 s29, 10
	s_waitcnt vmcnt(0)
	v_max3_u32 v8, v160, v164, v168
	v_max_u32 v8, v8, v172
	v_cmp_eq_u32 vcc, -1, v8
	s_cbranch_vccnz Lrep2_125
Lret2_136:
	s_waitcnt lgkmcnt(0)
	v_mfma_f32_16x16x32_bf16 v[64:67], v[160:163], v[32:35], v[64:67]
	v_mfma_f32_16x16x32_bf16 v[68:71], v[160:163], v[36:39], v[68:71]
	v_mfma_f32_16x16x32_bf16 v[72:75], v[160:163], v[40:43], v[72:75]
	v_mfma_f32_16x16x32_bf16 v[76:79], v[160:163], v[44:47], v[76:79]
	v_mfma_f32_16x16x32_bf16 v[80:83], v[164:167], v[32:35], v[80:83]
	v_mfma_f32_16x16x32_bf16 v[84:87], v[164:167], v[36:39], v[84:87]
	v_mfma_f32_16x16x32_bf16 v[88:91], v[164:167], v[40:43], v[88:91]
	v_mfma_f32_16x16x32_bf16 v[92:95], v[164:167], v[44:47], v[92:95]
	v_mfma_f32_16x16x32_bf16 v[96:99], v[168:171], v[32:35], v[96:99]
	v_mfma_f32_16x16x32_bf16 v[100:103], v[168:171], v[36:39], v[100:103]
	v_mfma_f32_16x16x32_bf16 v[104:107], v[168:171], v[40:43], v[104:107]
	v_mfma_f32_16x16x32_bf16 v[108:111], v[168:171], v[44:47], v[108:111]
	v_mfma_f32_16x16x32_bf16 v[112:115], v[172:175], v[32:35], v[112:115]
	v_mfma_f32_16x16x32_bf16 v[116:119], v[172:175], v[36:39], v[116:119]
	v_mfma_f32_16x16x32_bf16 v[120:123], v[172:175], v[40:43], v[120:123]
	v_mfma_f32_16x16x32_bf16 v[124:127], v[172:175], v[44:47], v[124:127]
L_145:
	s_waitcnt lgkmcnt(0)
	s_nop 7
	ds_write_b128 v28, v[68:71] offset:0
	ds_write_b128 v28, v[84:87] offset:1024
	ds_write_b128 v28, v[100:103] offset:2048
	ds_write_b128 v28, v[116:119] offset:3072
	ds_write_b128 v28, v[72:75] offset:4096
	ds_write_b128 v28, v[88:91] offset:5120
	ds_write_b128 v28, v[104:107] offset:6144
	ds_write_b128 v28, v[120:123] offset:7168
	ds_write_b128 v28, v[76:79] offset:8192
	ds_write_b128 v28, v[92:95] offset:9216
	ds_write_b128 v28, v[108:111] offset:10240
	ds_write_b128 v28, v[124:127] offset:11264
	s_waitcnt lgkmcnt(0)
	s_barrier
	ds_read_b128 v[128:131], v29 offset:0
	ds_read_b128 v[132:135], v30 offset:0
	ds_read_b128 v[136:139], v31 offset:0
	ds_read_b128 v[140:143], v29 offset:1024
	ds_read_b128 v[144:147], v30 offset:1024
	ds_read_b128 v[148:151], v31 offset:1024
	ds_read_b128 v[152:155], v29 offset:2048
	ds_read_b128 v[156:159], v30 offset:2048
	ds_read_b128 v[160:163], v31 offset:2048
	ds_read_b128 v[164:167], v29 offset:3072
	ds_read_b128 v[168:171], v30 offset:3072
	ds_read_b128 v[172:175], v31 offset:3072
	s_waitcnt lgkmcnt(9)
	v_add_f32 v64, v64, v128
	v_add_f32 v65, v65, v129
	v_add_f32 v66, v66, v130
	v_add_f32 v67, v67, v131
	v_add_f32 v64, v64, v132
	v_add_f32 v65, v65, v133
	v_add_f32 v66, v66, v134
	v_add_f32 v67, v67, v135
	v_add_f32 v64, v64, v136
	v_add_f32 v65, v65, v137
	v_add_f32 v66, v66, v138
	v_add_f32 v67, v67, v139
	v_cvt_pk_bf16_f32 v48, v64, v65
	v_cvt_pk_bf16_f32 v49, v66, v67
	v_lshlrev_b32 v64, 16, v48
	v_and_b32 v65, 0xffff0000, v48
	v_lshlrev_b32 v66, 16, v49
	v_and_b32 v67, 0xffff0000, v49
	v_add_f32 v64, v64, v26
	v_add_f32 v65, v65, v26
	v_add_f32 v66, v66, v26
	v_add_f32 v67, v67, v26
	v_cvt_pk_bf16_f32 v48, v64, v65
	v_cvt_pk_bf16_f32 v49, v66, v67
	v_lshlrev_b32 v64, 16, v48
	v_and_b32 v65, 0xffff0000, v48
	v_lshlrev_b32 v66, 16, v49
	v_and_b32 v67, 0xffff0000, v49
	v_lshlrev_b32 v50, 16, v16
	v_and_b32 v51, 0xffff0000, v16
	v_lshlrev_b32 v52, 16, v17
	v_and_b32 v53, 0xffff0000, v17
	v_add_f32 v64, v64, v50
	v_add_f32 v65, v65, v51
	v_add_f32 v66, v66, v52
	v_add_f32 v67, v67, v53
	v_cvt_pk_bf16_f32 v56, v64, v65
	v_cvt_pk_bf16_f32 v57, v66, v67
	s_waitcnt lgkmcnt(6)
	v_add_f32 v80, v80, v140
	v_add_f32 v81, v81, v141
	v_add_f32 v82, v82, v142
	v_add_f32 v83, v83, v143
	v_add_f32 v80, v80, v144
	v_add_f32 v81, v81, v145
	v_add_f32 v82, v82, v146
	v_add_f32 v83, v83, v147
	v_add_f32 v80, v80, v148
	v_add_f32 v81, v81, v149
	v_add_f32 v82, v82, v150
	v_add_f32 v83, v83, v151
	v_cvt_pk_bf16_f32 v48, v80, v81
	v_cvt_pk_bf16_f32 v49, v82, v83
	v_lshlrev_b32 v80, 16, v48
	v_and_b32 v81, 0xffff0000, v48
	v_lshlrev_b32 v82, 16, v49
	v_and_b32 v83, 0xffff0000, v49
	v_add_f32 v80, v80, v26
	v_add_f32 v81, v81, v26
	v_add_f32 v82, v82, v26
	v_add_f32 v83, v83, v26
	v_cvt_pk_bf16_f32 v48, v80, v81
	v_cvt_pk_bf16_f32 v49, v82, v83
	v_lshlrev_b32 v80, 16, v48
	v_and_b32 v81, 0xffff0000, v48
	v_lshlrev_b32 v82, 16, v49
	v_and_b32 v83, 0xffff0000, v49
	v_lshlrev_b32 v50, 16, v18
	v_and_b32 v51, 0xffff0000, v18
	v_lshlrev_b32 v52, 16, v19
	v_and_b32 v53, 0xffff0000, v19
	v_add_f32 v80, v80, v50
	v_add_f32 v81, v81, v51
	v_add_f32 v82, v82, v52
	v_add_f32 v83, v83, v53
	v_cvt_pk_bf16_f32 v58, v80, v81
	v_cvt_pk_bf16_f32 v59, v82, v83
	global_store_dwordx4 v25, v[56:59], s[60:61] offset:0
	s_waitcnt lgkmcnt(3)
	v_add_f32 v96, v96, v152
	v_add_f32 v97, v97, v153
	v_add_f32 v98, v98, v154
	v_add_f32 v99, v99, v155
	v_add_f32 v96, v96, v156
	v_add_f32 v97, v97, v157
	v_add_f32 v98, v98, v158
	v_add_f32 v99, v99, v159
	v_add_f32 v96, v96, v160
	v_add_f32 v97, v97, v161
	v_add_f32 v98, v98, v162
	v_add_f32 v99, v99, v163
	v_cvt_pk_bf16_f32 v48, v96, v97
	v_cvt_pk_bf16_f32 v49, v98, v99
	v_lshlrev_b32 v96, 16, v48
	v_and_b32 v97, 0xffff0000, v48
	v_lshlrev_b32 v98, 16, v49
	v_and_b32 v99, 0xffff0000, v49
	v_add_f32 v96, v96, v26
	v_add_f32 v97, v97, v26
	v_add_f32 v98, v98, v26
	v_add_f32 v99, v99, v26
	v_cvt_pk_bf16_f32 v48, v96, v97
	v_cvt_pk_bf16_f32 v49, v98, v99
	v_lshlrev_b32 v96, 16, v48
	v_and_b32 v97, 0xffff0000, v48
	v_lshlrev_b32 v98, 16, v49
	v_and_b32 v99, 0xffff0000, v49
	v_lshlrev_b32 v50, 16, v20
	v_and_b32 v51, 0xffff0000, v20
	v_lshlrev_b32 v52, 16, v21
	v_and_b32 v53, 0xffff0000, v21
	v_add_f32 v96, v96, v50
	v_add_f32 v97, v97, v51
	v_add_f32 v98, v98, v52
	v_add_f32 v99, v99, v53
	v_cvt_pk_bf16_f32 v60, v96, v97
	v_cvt_pk_bf16_f32 v61, v98, v99
	s_waitcnt lgkmcnt(0)
	v_add_f32 v112, v112, v164
	v_add_f32 v113, v113, v165
	v_add_f32 v114, v114, v166
	v_add_f32 v115, v115, v167
	v_add_f32 v112, v112, v168
	v_add_f32 v113, v113, v169
	v_add_f32 v114, v114, v170
	v_add_f32 v115, v115, v171
	v_add_f32 v112, v112, v172
	v_add_f32 v113, v113, v173
	v_add_f32 v114, v114, v174
	v_add_f32 v115, v115, v175
	v_cvt_pk_bf16_f32 v48, v112, v113
	v_cvt_pk_bf16_f32 v49, v114, v115
	v_lshlrev_b32 v112, 16, v48
	v_and_b32 v113, 0xffff0000, v48
	v_lshlrev_b32 v114, 16, v49
	v_and_b32 v115, 0xffff0000, v49
	v_add_f32 v112, v112, v26
	v_add_f32 v113, v113, v26
	v_add_f32 v114, v114, v26
	v_add_f32 v115, v115, v26
	v_cvt_pk_bf16_f32 v48, v112, v113
	v_cvt_pk_bf16_f32 v49, v114, v115
	v_lshlrev_b32 v112, 16, v48
	v_and_b32 v113, 0xffff0000, v48
	v_lshlrev_b32 v114, 16, v49
	v_and_b32 v115, 0xffff0000, v49
	v_lshlrev_b32 v50, 16, v22
	v_and_b32 v51, 0xffff0000, v22
	v_lshlrev_b32 v52, 16, v23
	v_and_b32 v53, 0xffff0000, v23
	v_add_f32 v112, v112, v50
	v_add_f32 v113, v113, v51
	v_add_f32 v114, v114, v52
	v_add_f32 v115, v115, v53
	v_cvt_pk_bf16_f32 v62, v112, v113
	v_cvt_pk_bf16_f32 v63, v114, v115
	global_store_dwordx4 v25, v[60:63], s[60:61] offset:64
	s_waitcnt vmcnt(0) lgkmcnt(0)
	s_or_b32 s30, s2, s3
	s_cmp_lg_u32 s30, 0
	s_cbranch_scc1 L_147
	v_mov_b32 v4, 13631488
	v_mov_b32 v6, s10
	v_mov_b32 v7, s11
	s_mov_b64 exec, 1
	global_store_dwordx2 v4, v[6:7], s[24:25]
	s_mov_b64 exec, -1
L_147:
L_end:
	s_endpgm
LT_23:
	ds_read_b64_tr_b16 a[0:1], v213 offset:0
	ds_read_b64_tr_b16 a[2:3], v213 offset:768
	ds_read_b64_tr_b16 a[4:5], v213 offset:8
	ds_read_b64_tr_b16 a[6:7], v213 offset:776
	ds_read_b64_tr_b16 a[8:9], v214 offset:0
	ds_read_b64_tr_b16 a[10:11], v214 offset:768
	ds_read_b64_tr_b16 a[12:13], v213 offset:3072
	ds_read_b64_tr_b16 a[14:15], v213 offset:3840
	ds_read_b64_tr_b16 a[16:17], v213 offset:3080
	ds_read_b64_tr_b16 a[18:19], v213 offset:3848
	ds_read_b64_tr_b16 a[20:21], v214 offset:3072
	ds_read_b64_tr_b16 a[22:23], v214 offset:3840
	ds_read_b64_tr_b16 a[24:25], v213 offset:6144
	ds_read_b64_tr_b16 a[26:27], v213 offset:6912
	ds_read_b64_tr_b16 a[28:29], v213 offset:6152
	ds_read_b64_tr_b16 a[30:31], v213 offset:6920
	ds_read_b64_tr_b16 a[32:33], v214 offset:6144
	ds_read_b64_tr_b16 a[34:35], v214 offset:6912
	ds_read_b64_tr_b16 a[36:37], v213 offset:9216
	ds_read_b64_tr_b16 a[38:39], v213 offset:9984
	ds_read_b64_tr_b16 a[40:41], v213 offset:9224
	ds_read_b64_tr_b16 a[42:43], v213 offset:9992
	ds_read_b64_tr_b16 a[44:45], v214 offset:9216
	ds_read_b64_tr_b16 a[46:47], v214 offset:9984
	ds_read_b64_tr_b16 a[48:49], v213 offset:12288
	ds_read_b64_tr_b16 a[50:51], v213 offset:13056
	ds_read_b64_tr_b16 a[52:53], v213 offset:12296
	ds_read_b64_tr_b16 a[54:55], v213 offset:13064
	ds_read_b64_tr_b16 a[56:57], v214 offset:12288
	ds_read_b64_tr_b16 a[58:59], v214 offset:13056
	ds_read_b64_tr_b16 a[60:61], v213 offset:15360
	ds_read_b64_tr_b16 a[62:63], v213 offset:16128
	ds_read_b64_tr_b16 a[64:65], v213 offset:15368
	ds_read_b64_tr_b16 a[66:67], v213 offset:16136
	ds_read_b64_tr_b16 a[68:69], v214 offset:15360
	ds_read_b64_tr_b16 a[70:71], v214 offset:16128
	ds_read_b64_tr_b16 a[72:73], v213 offset:18432
	ds_read_b64_tr_b16 a[74:75], v213 offset:19200
	ds_read_b64_tr_b16 a[76:77], v213 offset:18440
	ds_read_b64_tr_b16 a[78:79], v213 offset:19208
	ds_read_b64_tr_b16 a[80:81], v214 offset:18432
	ds_read_b64_tr_b16 a[82:83], v214 offset:19200
	ds_read_b64_tr_b16 a[84:85], v213 offset:21504
	ds_read_b64_tr_b16 a[86:87], v213 offset:22272
	ds_read_b64_tr_b16 a[88:89], v213 offset:21512
	ds_read_b64_tr_b16 a[90:91], v213 offset:22280
	ds_read_b64_tr_b16 a[92:93], v214 offset:21504
	ds_read_b64_tr_b16 a[94:95], v214 offset:22272
	v_mov_b32 v16, v10
	v_add_u32 v17, 0x8000, v11
	v_add_u32 v18, 0x10000, v10
	s_add_u32 s64, s68, 0
	s_addc_u32 s65, s69, 0
	s_mov_b32 s101, 131072
	s_mov_b32 s0, 4096
	s_mov_b32 s99, s66
	s_add_u32 s98, s98, 1
	s_waitcnt lgkmcnt(0)
	s_branch LTr_148
LTr_148:
	s_cmp_eq_u32 s63, 0
	s_cbranch_scc1 Ltr_22
	s_cmp_eq_u32 s63, 1
	s_cbranch_scc1 Ltr_27
	s_branch Ltr_40
LT_51:
	ds_read_b64_tr_b16 a[0:1], v213 offset:0
	ds_read_b64_tr_b16 a[2:3], v213 offset:768
	ds_read_b64_tr_b16 a[4:5], v213 offset:8
	ds_read_b64_tr_b16 a[6:7], v213 offset:776
	ds_read_b64_tr_b16 a[8:9], v214 offset:0
	ds_read_b64_tr_b16 a[10:11], v214 offset:768
	ds_read_b64_tr_b16 a[12:13], v213 offset:3072
	ds_read_b64_tr_b16 a[14:15], v213 offset:3840
	ds_read_b64_tr_b16 a[16:17], v213 offset:3080
	ds_read_b64_tr_b16 a[18:19], v213 offset:3848
	ds_read_b64_tr_b16 a[20:21], v214 offset:3072
	ds_read_b64_tr_b16 a[22:23], v214 offset:3840
	ds_read_b64_tr_b16 a[24:25], v213 offset:6144
	ds_read_b64_tr_b16 a[26:27], v213 offset:6912
	ds_read_b64_tr_b16 a[28:29], v213 offset:6152
	ds_read_b64_tr_b16 a[30:31], v213 offset:6920
	ds_read_b64_tr_b16 a[32:33], v214 offset:6144
	ds_read_b64_tr_b16 a[34:35], v214 offset:6912
	ds_read_b64_tr_b16 a[36:37], v213 offset:9216
	ds_read_b64_tr_b16 a[38:39], v213 offset:9984
	ds_read_b64_tr_b16 a[40:41], v213 offset:9224
	ds_read_b64_tr_b16 a[42:43], v213 offset:9992
	ds_read_b64_tr_b16 a[44:45], v214 offset:9216
	ds_read_b64_tr_b16 a[46:47], v214 offset:9984
	ds_read_b64_tr_b16 a[48:49], v213 offset:12288
	ds_read_b64_tr_b16 a[50:51], v213 offset:13056
	ds_read_b64_tr_b16 a[52:53], v213 offset:12296
	ds_read_b64_tr_b16 a[54:55], v213 offset:13064
	ds_read_b64_tr_b16 a[56:57], v214 offset:12288
	ds_read_b64_tr_b16 a[58:59], v214 offset:13056
	ds_read_b64_tr_b16 a[60:61], v213 offset:15360
	ds_read_b64_tr_b16 a[62:63], v213 offset:16128
	ds_read_b64_tr_b16 a[64:65], v213 offset:15368
	ds_read_b64_tr_b16 a[66:67], v213 offset:16136
	ds_read_b64_tr_b16 a[68:69], v214 offset:15360
	ds_read_b64_tr_b16 a[70:71], v214 offset:16128
	ds_read_b64_tr_b16 a[72:73], v213 offset:18432
	ds_read_b64_tr_b16 a[74:75], v213 offset:19200
	ds_read_b64_tr_b16 a[76:77], v213 offset:18440
	ds_read_b64_tr_b16 a[78:79], v213 offset:19208
	ds_read_b64_tr_b16 a[80:81], v214 offset:18432
	ds_read_b64_tr_b16 a[82:83], v214 offset:19200
	ds_read_b64_tr_b16 a[84:85], v213 offset:21504
	ds_read_b64_tr_b16 a[86:87], v213 offset:22272
	ds_read_b64_tr_b16 a[88:89], v213 offset:21512
	ds_read_b64_tr_b16 a[90:91], v213 offset:22280
	ds_read_b64_tr_b16 a[92:93], v214 offset:21504
	ds_read_b64_tr_b16 a[94:95], v214 offset:22272
	v_mov_b32 v16, v10
	v_add_u32 v17, 0x8000, v11
	v_add_u32 v18, 0x10000, v10
	s_add_u32 s64, s68, 0
	s_addc_u32 s65, s69, 0
	s_mov_b32 s101, 131072
	s_mov_b32 s0, 4096
	s_mov_b32 s99, s66
	s_add_u32 s98, s98, 1
	s_waitcnt lgkmcnt(0)
	s_branch LTr_149
LT_53:
	ds_read_b64_tr_b16 a[96:97], v213 offset:0
	ds_read_b64_tr_b16 a[98:99], v213 offset:768
	ds_read_b64_tr_b16 a[100:101], v213 offset:8
	ds_read_b64_tr_b16 a[102:103], v213 offset:776
	ds_read_b64_tr_b16 a[104:105], v214 offset:0
	ds_read_b64_tr_b16 a[106:107], v214 offset:768
	ds_read_b64_tr_b16 a[108:109], v213 offset:3072
	ds_read_b64_tr_b16 a[110:111], v213 offset:3840
	ds_read_b64_tr_b16 a[112:113], v213 offset:3080
	ds_read_b64_tr_b16 a[114:115], v213 offset:3848
	ds_read_b64_tr_b16 a[116:117], v214 offset:3072
	ds_read_b64_tr_b16 a[118:119], v214 offset:3840
	ds_read_b64_tr_b16 a[120:121], v213 offset:6144
	ds_read_b64_tr_b16 a[122:123], v213 offset:6912
	ds_read_b64_tr_b16 a[124:125], v213 offset:6152
	ds_read_b64_tr_b16 a[126:127], v213 offset:6920
	ds_read_b64_tr_b16 a[128:129], v214 offset:6144
	ds_read_b64_tr_b16 a[130:131], v214 offset:6912
	ds_read_b64_tr_b16 a[132:133], v213 offset:9216
	ds_read_b64_tr_b16 a[134:135], v213 offset:9984
	ds_read_b64_tr_b16 a[136:137], v213 offset:9224
	ds_read_b64_tr_b16 a[138:139], v213 offset:9992
	ds_read_b64_tr_b16 a[140:141], v214 offset:9216
	ds_read_b64_tr_b16 a[142:143], v214 offset:9984
	ds_read_b64_tr_b16 a[144:145], v213 offset:12288
	ds_read_b64_tr_b16 a[146:147], v213 offset:13056
	ds_read_b64_tr_b16 a[148:149], v213 offset:12296
	ds_read_b64_tr_b16 a[150:151], v213 offset:13064
	ds_read_b64_tr_b16 a[152:153], v214 offset:12288
	ds_read_b64_tr_b16 a[154:155], v214 offset:13056
	ds_read_b64_tr_b16 a[156:157], v213 offset:15360
	ds_read_b64_tr_b16 a[158:159], v213 offset:16128
	ds_read_b64_tr_b16 a[160:161], v213 offset:15368
	ds_read_b64_tr_b16 a[162:163], v213 offset:16136
	ds_read_b64_tr_b16 a[164:165], v214 offset:15360
	ds_read_b64_tr_b16 a[166:167], v214 offset:16128
	ds_read_b64_tr_b16 a[168:169], v213 offset:18432
	ds_read_b64_tr_b16 a[170:171], v213 offset:19200
	ds_read_b64_tr_b16 a[172:173], v213 offset:18440
	ds_read_b64_tr_b16 a[174:175], v213 offset:19208
	ds_read_b64_tr_b16 a[176:177], v214 offset:18432
	ds_read_b64_tr_b16 a[178:179], v214 offset:19200
	ds_read_b64_tr_b16 a[180:181], v213 offset:21504
	ds_read_b64_tr_b16 a[182:183], v213 offset:22272
	ds_read_b64_tr_b16 a[184:185], v213 offset:21512
	ds_read_b64_tr_b16 a[186:187], v213 offset:22280
	ds_read_b64_tr_b16 a[188:189], v214 offset:21504
	ds_read_b64_tr_b16 a[190:191], v214 offset:22272
	v_mov_b32 v16, v10
	v_add_u32 v17, 0x8000, v11
	v_add_u32 v18, 0x10000, v10
	s_add_u32 s64, s68, 524288
	s_addc_u32 s65, s69, 0
	s_mov_b32 s101, 131072
	s_mov_b32 s0, 4096
	s_mov_b32 s99, s66
	s_add_u32 s98, s98, 1
	s_waitcnt lgkmcnt(0)
	s_branch LTr_149
LT_52:
	ds_read_b64_tr_b16 a[192:193], v12 offset:0
	ds_read_b64_tr_b16 a[194:195], v12 offset:512
	ds_read_b64_tr_b16 a[196:197], v13 offset:0
	ds_read_b64_tr_b16 a[198:199], v13 offset:512
	ds_read_b64_tr_b16 a[200:201], v14 offset:0
	ds_read_b64_tr_b16 a[202:203], v14 offset:512
	ds_read_b64_tr_b16 a[204:205], v15 offset:0
	ds_read_b64_tr_b16 a[206:207], v15 offset:512
	ds_read_b64_tr_b16 a[208:209], v12 offset:4096
	ds_read_b64_tr_b16 a[210:211], v12 offset:4608
	ds_read_b64_tr_b16 a[212:213], v13 offset:4096
	ds_read_b64_tr_b16 a[214:215], v13 offset:4608
	ds_read_b64_tr_b16 a[216:217], v14 offset:4096
	ds_read_b64_tr_b16 a[218:219], v14 offset:4608
	ds_read_b64_tr_b16 a[220:221], v15 offset:4096
	ds_read_b64_tr_b16 a[222:223], v15 offset:4608
	ds_read_b64_tr_b16 a[224:225], v12 offset:8192
	ds_read_b64_tr_b16 a[226:227], v12 offset:8704
	ds_read_b64_tr_b16 a[228:229], v13 offset:8192
	ds_read_b64_tr_b16 a[230:231], v13 offset:8704
	ds_read_b64_tr_b16 a[232:233], v14 offset:8192
	ds_read_b64_tr_b16 a[234:235], v14 offset:8704
	ds_read_b64_tr_b16 a[236:237], v15 offset:8192
	ds_read_b64_tr_b16 a[238:239], v15 offset:8704
	ds_read_b64_tr_b16 a[240:241], v12 offset:12288
	ds_read_b64_tr_b16 a[242:243], v12 offset:12800
	ds_read_b64_tr_b16 a[244:245], v13 offset:12288
	ds_read_b64_tr_b16 a[246:247], v13 offset:12800
	ds_read_b64_tr_b16 a[248:249], v14 offset:12288
	ds_read_b64_tr_b16 a[250:251], v14 offset:12800
	ds_read_b64_tr_b16 a[252:253], v15 offset:12288
	ds_read_b64_tr_b16 a[254:255], v15 offset:12800
	v_mov_b32 v16, v210
	v_mov_b32 v17, v211
	v_mov_b32 v18, v212
	s_mul_i32 s99, s3, 1409024
	s_lshl_b32 s0, s96, 1
	s_add_u32 s99, s99, s0
	s_add_u32 s99, s99, 704512
	s_and_b32 s62, s100, 3
	s_mul_i32 s62, s62, 0
	s_sub_u32 s1, 8, s62
	s_mul_i32 s62, s62, 88064
	s_add_u32 s99, s99, s62
	s_mov_b32 s22, 704512
	s_add_u32 s64, s12, s99
	s_addc_u32 s65, s13, 0
	s_mov_b32 s101, 88064
	s_mov_b32 s0, 3072
	s_mov_b32 s99, s66
	s_add_u32 s98, s98, 1
	s_waitcnt lgkmcnt(0)
	s_branch LTr_149
LTr_149:
	s_cmp_eq_u32 s63, 0
	s_cbranch_scc1 Ltr_50
	s_cmp_eq_u32 s63, 1
	s_cbranch_scc1 Ltr_57
	s_cmp_eq_u32 s63, 2
	s_cbranch_scc1 Ltr_69
	s_branch Ltr_76
Lrep1_77:
	s_waitcnt vmcnt(0)
	s_and_b32 s31, s29, 7
	s_cmp_eq_u32 s31, 1
	s_cbranch_scc1 Lrp_154
	s_cmp_eq_u32 s31, 2
	s_cbranch_scc1 Lrp_155
	s_cmp_eq_u32 s31, 3
	s_cbranch_scc1 Lrp_156
	s_cmp_eq_u32 s31, 4
	s_cbranch_scc1 Lrp_157
	s_cmp_eq_u32 s31, 5
	s_cbranch_scc1 Lrp_158
	s_cmp_eq_u32 s31, 6
	s_cbranch_scc1 Lrp_159
	s_cmp_eq_u32 s31, 7
	s_cbranch_scc1 Lrp_160
Lrp_153:
	v_max3_u32 v8, v128, v132, v136
	v_max_u32 v8, v8, v140
	v_cmp_eq_u32 vcc, -1, v8
	s_cbranch_vccz Lrt_152
	s_add_u32 s28, s28, 1
	s_cmp_gt_u32 s28, 20000
	s_cbranch_scc1 Lrr_151
	global_load_dwordx4 v[128:131], v24, s[40:41] sc1
	global_load_dwordx4 v[132:135], v25, s[40:41] sc1
	global_load_dwordx4 v[136:139], v26, s[40:41] sc1
	global_load_dwordx4 v[140:143], v27, s[40:41] sc1
	s_waitcnt vmcnt(0)
	s_branch Lrp_153
Lrp_154:
	v_max3_u32 v8, v144, v148, v152
	v_max_u32 v8, v8, v156
	v_cmp_eq_u32 vcc, -1, v8
	s_cbranch_vccz Lrt_152
	s_add_u32 s28, s28, 1
	s_cmp_gt_u32 s28, 20000
	s_cbranch_scc1 Lrr_151
	global_load_dwordx4 v[144:147], v24, s[42:43] sc1
	global_load_dwordx4 v[148:151], v25, s[42:43] sc1
	global_load_dwordx4 v[152:155], v26, s[42:43] sc1
	global_load_dwordx4 v[156:159], v27, s[42:43] sc1
	s_waitcnt vmcnt(0)
	s_branch Lrp_154
Lrp_155:
	v_max3_u32 v8, v160, v164, v168
	v_max_u32 v8, v8, v172
	v_cmp_eq_u32 vcc, -1, v8
	s_cbranch_vccz Lrt_152
	s_add_u32 s28, s28, 1
	s_cmp_gt_u32 s28, 20000
	s_cbranch_scc1 Lrr_151
	global_load_dwordx4 v[160:163], v24, s[44:45] sc1
	global_load_dwordx4 v[164:167], v25, s[44:45] sc1
	global_load_dwordx4 v[168:171], v26, s[44:45] sc1
	global_load_dwordx4 v[172:175], v27, s[44:45] sc1
	s_waitcnt vmcnt(0)
	s_branch Lrp_155
Lrp_156:
	v_max3_u32 v8, v176, v180, v184
	v_max_u32 v8, v8, v188
	v_cmp_eq_u32 vcc, -1, v8
	s_cbranch_vccz Lrt_152
	s_add_u32 s28, s28, 1
	s_cmp_gt_u32 s28, 20000
	s_cbranch_scc1 Lrr_151
	global_load_dwordx4 v[176:179], v24, s[46:47] sc1
	global_load_dwordx4 v[180:183], v25, s[46:47] sc1
	global_load_dwordx4 v[184:187], v26, s[46:47] sc1
	global_load_dwordx4 v[188:191], v27, s[46:47] sc1
	s_waitcnt vmcnt(0)
	s_branch Lrp_156
Lrp_157:
	v_max3_u32 v8, v192, v196, v200
	v_max_u32 v8, v8, v204
	v_cmp_eq_u32 vcc, -1, v8
	s_cbranch_vccz Lrt_152
	s_add_u32 s28, s28, 1
	s_cmp_gt_u32 s28, 20000
	s_cbranch_scc1 Lrr_151
	global_load_dwordx4 v[192:195], v24, s[48:49] sc1
	global_load_dwordx4 v[196:199], v25, s[48:49] sc1
	global_load_dwordx4 v[200:203], v26, s[48:49] sc1
	global_load_dwordx4 v[204:207], v27, s[48:49] sc1
	s_waitcnt vmcnt(0)
	s_branch Lrp_157
Lrp_158:
	v_max3_u32 v8, v208, v212, v216
	v_max_u32 v8, v8, v220
	v_cmp_eq_u32 vcc, -1, v8
	s_cbranch_vccz Lrt_152
	s_add_u32 s28, s28, 1
	s_cmp_gt_u32 s28, 20000
	s_cbranch_scc1 Lrr_151
	global_load_dwordx4 v[208:211], v24, s[50:51] sc1
	global_load_dwordx4 v[212:215], v25, s[50:51] sc1
	global_load_dwordx4 v[216:219], v26, s[50:51] sc1
	global_load_dwordx4 v[220:223], v27, s[50:51] sc1
	s_waitcnt vmcnt(0)
	s_branch Lrp_158
Lrp_159:
	v_max3_u32 v8, v224, v228, v232
	v_max_u32 v8, v8, v236
	v_cmp_eq_u32 vcc, -1, v8
	s_cbranch_vccz Lrt_152
	s_add_u32 s28, s28, 1
	s_cmp_gt_u32 s28, 20000
	s_cbranch_scc1 Lrr_151
	global_load_dwordx4 v[224:227], v24, s[52:53] sc1
	global_load_dwordx4 v[228:231], v25, s[52:53] sc1
	global_load_dwordx4 v[232:235], v26, s[52:53] sc1
	global_load_dwordx4 v[236:239], v27, s[52:53] sc1
	s_waitcnt vmcnt(0)
	s_branch Lrp_159
Lrp_160:
	v_max3_u32 v8, v240, v244, v248
	v_max_u32 v8, v8, v252
	v_cmp_eq_u32 vcc, -1, v8
	s_cbranch_vccz Lrt_152
	s_add_u32 s28, s28, 1
	s_cmp_gt_u32 s28, 20000
	s_cbranch_scc1 Lrr_151
	global_load_dwordx4 v[240:243], v24, s[54:55] sc1
	global_load_dwordx4 v[244:247], v25, s[54:55] sc1
	global_load_dwordx4 v[248:251], v26, s[54:55] sc1
	global_load_dwordx4 v[252:255], v27, s[54:55] sc1
	s_waitcnt vmcnt(0)
	s_branch Lrp_160
Lrt_152:
	v_max3_u32 v8, v128, v132, v136
	v_max_u32 v8, v8, v140
	v_cmp_eq_u32 vcc, -1, v8
	s_cbranch_vccz L_161
	global_load_dwordx4 v[128:131], v24, s[40:41] sc1
	global_load_dwordx4 v[132:135], v25, s[40:41] sc1
	global_load_dwordx4 v[136:139], v26, s[40:41] sc1
	global_load_dwordx4 v[140:143], v27, s[40:41] sc1
L_161:
	v_max3_u32 v8, v144, v148, v152
	v_max_u32 v8, v8, v156
	v_cmp_eq_u32 vcc, -1, v8
	s_cbranch_vccz L_162
	global_load_dwordx4 v[144:147], v24, s[42:43] sc1
	global_load_dwordx4 v[148:151], v25, s[42:43] sc1
	global_load_dwordx4 v[152:155], v26, s[42:43] sc1
	global_load_dwordx4 v[156:159], v27, s[42:43] sc1
L_162:
	v_max3_u32 v8, v160, v164, v168
	v_max_u32 v8, v8, v172
	v_cmp_eq_u32 vcc, -1, v8
	s_cbranch_vccz L_163
	global_load_dwordx4 v[160:163], v24, s[44:45] sc1
	global_load_dwordx4 v[164:167], v25, s[44:45] sc1
	global_load_dwordx4 v[168:171], v26, s[44:45] sc1
	global_load_dwordx4 v[172:175], v27, s[44:45] sc1
L_163:
	v_max3_u32 v8, v176, v180, v184
	v_max_u32 v8, v8, v188
	v_cmp_eq_u32 vcc, -1, v8
	s_cbranch_vccz L_164
	global_load_dwordx4 v[176:179], v24, s[46:47] sc1
	global_load_dwordx4 v[180:183], v25, s[46:47] sc1
	global_load_dwordx4 v[184:187], v26, s[46:47] sc1
	global_load_dwordx4 v[188:191], v27, s[46:47] sc1
L_164:
	v_max3_u32 v8, v192, v196, v200
	v_max_u32 v8, v8, v204
	v_cmp_eq_u32 vcc, -1, v8
	s_cbranch_vccz L_165
	global_load_dwordx4 v[192:195], v24, s[48:49] sc1
	global_load_dwordx4 v[196:199], v25, s[48:49] sc1
	global_load_dwordx4 v[200:203], v26, s[48:49] sc1
	global_load_dwordx4 v[204:207], v27, s[48:49] sc1
L_165:
	v_max3_u32 v8, v208, v212, v216
	v_max_u32 v8, v8, v220
	v_cmp_eq_u32 vcc, -1, v8
	s_cbranch_vccz L_166
	global_load_dwordx4 v[208:211], v24, s[50:51] sc1
	global_load_dwordx4 v[212:215], v25, s[50:51] sc1
	global_load_dwordx4 v[216:219], v26, s[50:51] sc1
	global_load_dwordx4 v[220:223], v27, s[50:51] sc1
L_166:
	v_max3_u32 v8, v224, v228, v232
	v_max_u32 v8, v8, v236
	v_cmp_eq_u32 vcc, -1, v8
	s_cbranch_vccz L_167
	global_load_dwordx4 v[224:227], v24, s[52:53] sc1
	global_load_dwordx4 v[228:231], v25, s[52:53] sc1
	global_load_dwordx4 v[232:235], v26, s[52:53] sc1
	global_load_dwordx4 v[236:239], v27, s[52:53] sc1
L_167:
	v_max3_u32 v8, v240, v244, v248
	v_max_u32 v8, v8, v252
	v_cmp_eq_u32 vcc, -1, v8
	s_cbranch_vccz L_168
	global_load_dwordx4 v[240:243], v24, s[54:55] sc1
	global_load_dwordx4 v[244:247], v25, s[54:55] sc1
	global_load_dwordx4 v[248:251], v26, s[54:55] sc1
	global_load_dwordx4 v[252:255], v27, s[54:55] sc1
L_168:
	s_waitcnt vmcnt(0)
Lrr_151:
	s_cmp_eq_u32 s29, 0
	s_cbranch_scc1 Lret1_78
	s_cmp_eq_u32 s29, 1
	s_cbranch_scc1 Lret1_79
	s_cmp_eq_u32 s29, 2
	s_cbranch_scc1 Lret1_80
	s_cmp_eq_u32 s29, 3
	s_cbranch_scc1 Lret1_81
	s_cmp_eq_u32 s29, 4
	s_cbranch_scc1 Lret1_82
	s_cmp_eq_u32 s29, 5
	s_cbranch_scc1 Lret1_83
	s_cmp_eq_u32 s29, 6
	s_cbranch_scc1 Lret1_84
	s_cmp_eq_u32 s29, 7
	s_cbranch_scc1 Lret1_85
	s_cmp_eq_u32 s29, 8
	s_cbranch_scc1 Lret1_86
	s_cmp_eq_u32 s29, 9
	s_cbranch_scc1 Lret1_87
	s_cmp_eq_u32 s29, 10
	s_cbranch_scc1 Lret1_88
	s_cmp_eq_u32 s29, 11
	s_cbranch_scc1 Lret1_89
	s_cmp_eq_u32 s29, 12
	s_cbranch_scc1 Lret1_90
	s_cmp_eq_u32 s29, 13
	s_cbranch_scc1 Lret1_91
	s_cmp_eq_u32 s29, 14
	s_cbranch_scc1 Lret1_92
	s_branch Lret1_93
LT_97:
	ds_read_b64_tr_b16 a[0:1], v213 offset:0
	ds_read_b64_tr_b16 a[2:3], v213 offset:768
	ds_read_b64_tr_b16 a[4:5], v213 offset:8
	ds_read_b64_tr_b16 a[6:7], v213 offset:776
	ds_read_b64_tr_b16 a[8:9], v214 offset:0
	ds_read_b64_tr_b16 a[10:11], v214 offset:768
	ds_read_b64_tr_b16 a[12:13], v213 offset:3072
	ds_read_b64_tr_b16 a[14:15], v213 offset:3840
	ds_read_b64_tr_b16 a[16:17], v213 offset:3080
	ds_read_b64_tr_b16 a[18:19], v213 offset:3848
	ds_read_b64_tr_b16 a[20:21], v214 offset:3072
	ds_read_b64_tr_b16 a[22:23], v214 offset:3840
	ds_read_b64_tr_b16 a[24:25], v213 offset:6144
	ds_read_b64_tr_b16 a[26:27], v213 offset:6912
	ds_read_b64_tr_b16 a[28:29], v213 offset:6152
	ds_read_b64_tr_b16 a[30:31], v213 offset:6920
	ds_read_b64_tr_b16 a[32:33], v214 offset:6144
	ds_read_b64_tr_b16 a[34:35], v214 offset:6912
	ds_read_b64_tr_b16 a[36:37], v213 offset:9216
	ds_read_b64_tr_b16 a[38:39], v213 offset:9984
	ds_read_b64_tr_b16 a[40:41], v213 offset:9224
	ds_read_b64_tr_b16 a[42:43], v213 offset:9992
	ds_read_b64_tr_b16 a[44:45], v214 offset:9216
	ds_read_b64_tr_b16 a[46:47], v214 offset:9984
	ds_read_b64_tr_b16 a[48:49], v213 offset:12288
	ds_read_b64_tr_b16 a[50:51], v213 offset:13056
	ds_read_b64_tr_b16 a[52:53], v213 offset:12296
	ds_read_b64_tr_b16 a[54:55], v213 offset:13064
	ds_read_b64_tr_b16 a[56:57], v214 offset:12288
	ds_read_b64_tr_b16 a[58:59], v214 offset:13056
	ds_read_b64_tr_b16 a[60:61], v213 offset:15360
	ds_read_b64_tr_b16 a[62:63], v213 offset:16128
	ds_read_b64_tr_b16 a[64:65], v213 offset:15368
	ds_read_b64_tr_b16 a[66:67], v213 offset:16136
	ds_read_b64_tr_b16 a[68:69], v214 offset:15360
	ds_read_b64_tr_b16 a[70:71], v214 offset:16128
	ds_read_b64_tr_b16 a[72:73], v213 offset:18432
	ds_read_b64_tr_b16 a[74:75], v213 offset:19200
	ds_read_b64_tr_b16 a[76:77], v213 offset:18440
	ds_read_b64_tr_b16 a[78:79], v213 offset:19208
	ds_read_b64_tr_b16 a[80:81], v214 offset:18432
	ds_read_b64_tr_b16 a[82:83], v214 offset:19200
	ds_read_b64_tr_b16 a[84:85], v213 offset:21504
	ds_read_b64_tr_b16 a[86:87], v213 offset:22272
	ds_read_b64_tr_b16 a[88:89], v213 offset:21512
	ds_read_b64_tr_b16 a[90:91], v213 offset:22280
	ds_read_b64_tr_b16 a[92:93], v214 offset:21504
	ds_read_b64_tr_b16 a[94:95], v214 offset:22272
	v_mov_b32 v16, v10
	v_add_u32 v17, 0x8000, v11
	v_add_u32 v18, 0x10000, v10
	s_add_u32 s64, s68, 0
	s_addc_u32 s65, s69, 0
	s_mov_b32 s101, 131072
	s_mov_b32 s0, 4096
	s_mov_b32 s99, s66
	s_add_u32 s98, s98, 1
	s_waitcnt lgkmcnt(0)
	s_branch LTr_169
LT_99:
	ds_read_b64_tr_b16 a[96:97], v213 offset:0
	ds_read_b64_tr_b16 a[98:99], v213 offset:768
	ds_read_b64_tr_b16 a[100:101], v213 offset:8
	ds_read_b64_tr_b16 a[102:103], v213 offset:776
	ds_read_b64_tr_b16 a[104:105], v214 offset:0
	ds_read_b64_tr_b16 a[106:107], v214 offset:768
	ds_read_b64_tr_b16 a[108:109], v213 offset:3072
	ds_read_b64_tr_b16 a[110:111], v213 offset:3840
	ds_read_b64_tr_b16 a[112:113], v213 offset:3080
	ds_read_b64_tr_b16 a[114:115], v213 offset:3848
	ds_read_b64_tr_b16 a[116:117], v214 offset:3072
	ds_read_b64_tr_b16 a[118:119], v214 offset:3840
	ds_read_b64_tr_b16 a[120:121], v213 offset:6144
	ds_read_b64_tr_b16 a[122:123], v213 offset:6912
	ds_read_b64_tr_b16 a[124:125], v213 offset:6152
	ds_read_b64_tr_b16 a[126:127], v213 offset:6920
	ds_read_b64_tr_b16 a[128:129], v214 offset:6144
	ds_read_b64_tr_b16 a[130:131], v214 offset:6912
	ds_read_b64_tr_b16 a[132:133], v213 offset:9216
	ds_read_b64_tr_b16 a[134:135], v213 offset:9984
	ds_read_b64_tr_b16 a[136:137], v213 offset:9224
	ds_read_b64_tr_b16 a[138:139], v213 offset:9992
	ds_read_b64_tr_b16 a[140:141], v214 offset:9216
	ds_read_b64_tr_b16 a[142:143], v214 offset:9984
	ds_read_b64_tr_b16 a[144:145], v213 offset:12288
	ds_read_b64_tr_b16 a[146:147], v213 offset:13056
	ds_read_b64_tr_b16 a[148:149], v213 offset:12296
	ds_read_b64_tr_b16 a[150:151], v213 offset:13064
	ds_read_b64_tr_b16 a[152:153], v214 offset:12288
	ds_read_b64_tr_b16 a[154:155], v214 offset:13056
	ds_read_b64_tr_b16 a[156:157], v213 offset:15360
	ds_read_b64_tr_b16 a[158:159], v213 offset:16128
	ds_read_b64_tr_b16 a[160:161], v213 offset:15368
	ds_read_b64_tr_b16 a[162:163], v213 offset:16136
	ds_read_b64_tr_b16 a[164:165], v214 offset:15360
	ds_read_b64_tr_b16 a[166:167], v214 offset:16128
	ds_read_b64_tr_b16 a[168:169], v213 offset:18432
	ds_read_b64_tr_b16 a[170:171], v213 offset:19200
	ds_read_b64_tr_b16 a[172:173], v213 offset:18440
	ds_read_b64_tr_b16 a[174:175], v213 offset:19208
	ds_read_b64_tr_b16 a[176:177], v214 offset:18432
	ds_read_b64_tr_b16 a[178:179], v214 offset:19200
	ds_read_b64_tr_b16 a[180:181], v213 offset:21504
	ds_read_b64_tr_b16 a[182:183], v213 offset:22272
	ds_read_b64_tr_b16 a[184:185], v213 offset:21512
	ds_read_b64_tr_b16 a[186:187], v213 offset:22280
	ds_read_b64_tr_b16 a[188:189], v214 offset:21504
	ds_read_b64_tr_b16 a[190:191], v214 offset:22272
	v_mov_b32 v16, v10
	v_add_u32 v17, 0x8000, v11
	v_add_u32 v18, 0x10000, v10
	s_add_u32 s64, s68, 524288
	s_addc_u32 s65, s69, 0
	s_mov_b32 s101, 131072
	s_mov_b32 s0, 4096
	s_mov_b32 s99, s66
	s_add_u32 s98, s98, 1
	s_waitcnt lgkmcnt(0)
	s_branch LTr_169
LT_98:
	ds_read_b64_tr_b16 a[192:193], v12 offset:0
	ds_read_b64_tr_b16 a[194:195], v12 offset:512
	ds_read_b64_tr_b16 a[196:197], v13 offset:0
	ds_read_b64_tr_b16 a[198:199], v13 offset:512
	ds_read_b64_tr_b16 a[200:201], v14 offset:0
	ds_read_b64_tr_b16 a[202:203], v14 offset:512
	ds_read_b64_tr_b16 a[204:205], v15 offset:0
	ds_read_b64_tr_b16 a[206:207], v15 offset:512
	ds_read_b64_tr_b16 a[208:209], v12 offset:4096
	ds_read_b64_tr_b16 a[210:211], v12 offset:4608
	ds_read_b64_tr_b16 a[212:213], v13 offset:4096
	ds_read_b64_tr_b16 a[214:215], v13 offset:4608
	ds_read_b64_tr_b16 a[216:217], v14 offset:4096
	ds_read_b64_tr_b16 a[218:219], v14 offset:4608
	ds_read_b64_tr_b16 a[220:221], v15 offset:4096
	ds_read_b64_tr_b16 a[222:223], v15 offset:4608
	ds_read_b64_tr_b16 a[224:225], v12 offset:8192
	ds_read_b64_tr_b16 a[226:227], v12 offset:8704
	ds_read_b64_tr_b16 a[228:229], v13 offset:8192
	ds_read_b64_tr_b16 a[230:231], v13 offset:8704
	ds_read_b64_tr_b16 a[232:233], v14 offset:8192
	ds_read_b64_tr_b16 a[234:235], v14 offset:8704
	ds_read_b64_tr_b16 a[236:237], v15 offset:8192
	ds_read_b64_tr_b16 a[238:239], v15 offset:8704
	ds_read_b64_tr_b16 a[240:241], v12 offset:12288
	ds_read_b64_tr_b16 a[242:243], v12 offset:12800
	ds_read_b64_tr_b16 a[244:245], v13 offset:12288
	ds_read_b64_tr_b16 a[246:247], v13 offset:12800
	ds_read_b64_tr_b16 a[248:249], v14 offset:12288
	ds_read_b64_tr_b16 a[250:251], v14 offset:12800
	ds_read_b64_tr_b16 a[252:253], v15 offset:12288
	ds_read_b64_tr_b16 a[254:255], v15 offset:12800
	v_mov_b32 v16, v210
	v_mov_b32 v17, v211
	v_mov_b32 v18, v212
	s_mul_i32 s99, s3, 1409024
	s_lshl_b32 s0, s96, 1
	s_add_u32 s99, s99, s0
	s_add_u32 s99, s99, 704512
	s_and_b32 s62, s100, 3
	s_mul_i32 s62, s62, 0
	s_sub_u32 s1, 8, s62
	s_mul_i32 s62, s62, 88064
	s_add_u32 s99, s99, s62
	s_mov_b32 s22, 704512
	s_add_u32 s64, s12, s99
	s_addc_u32 s65, s13, 0
	s_mov_b32 s101, 88064
	s_mov_b32 s0, 3072
	s_mov_b32 s99, s66
	s_add_u32 s98, s98, 1
	s_waitcnt lgkmcnt(0)
	s_branch LTr_169
LTr_169:
	s_cmp_eq_u32 s63, 0
	s_cbranch_scc1 Ltr_96
	s_branch Ltr_102
Lfs_105:
Lfp_103:
	s_add_u32 s28, s28, 1
	s_cmp_gt_u32 s28, 20000
	s_cbranch_scc1 Lfv_106
	global_load_dwordx4 v[128:131], v24, s[40:41] sc1
	global_load_dwordx4 v[132:135], v25, s[40:41] sc1
	global_load_dwordx4 v[136:139], v26, s[40:41] sc1
	global_load_dwordx4 v[140:143], v27, s[40:41] sc1
	s_waitcnt vmcnt(0)
	v_max3_u32 v8, v128, v132, v136
	v_max_u32 v8, v8, v140
	v_cmp_eq_u32 vcc, -1, v8
	s_cbranch_vccnz Lfp_103
Lfv_106:
	s_add_u32 s42, s56, 32768
	s_addc_u32 s43, s57, 0
	global_load_dwordx4 v[144:147], v24, s[42:43] sc1
	global_load_dwordx4 v[148:151], v25, s[42:43] sc1
	global_load_dwordx4 v[152:155], v26, s[42:43] sc1
	global_load_dwordx4 v[156:159], v27, s[42:43] sc1
	s_add_u32 s44, s56, 65536
	s_addc_u32 s45, s57, 0
	global_load_dwordx4 v[160:163], v24, s[44:45] sc1
	global_load_dwordx4 v[164:167], v25, s[44:45] sc1
	global_load_dwordx4 v[168:171], v26, s[44:45] sc1
	global_load_dwordx4 v[172:175], v27, s[44:45] sc1
	s_add_u32 s46, s56, 98304
	s_addc_u32 s47, s57, 0
	global_load_dwordx4 v[176:179], v24, s[46:47] sc1
	global_load_dwordx4 v[180:183], v25, s[46:47] sc1
	global_load_dwordx4 v[184:187], v26, s[46:47] sc1
	global_load_dwordx4 v[188:191], v27, s[46:47] sc1
	s_add_u32 s48, s56, 131072
	s_addc_u32 s49, s57, 0
	global_load_dwordx4 v[192:195], v24, s[48:49] sc1
	global_load_dwordx4 v[196:199], v25, s[48:49] sc1
	global_load_dwordx4 v[200:203], v26, s[48:49] sc1
	global_load_dwordx4 v[204:207], v27, s[48:49] sc1
	s_branch Lfd_104
Lrep2_125:
	s_waitcnt vmcnt(0)
	s_and_b32 s31, s29, 7
	s_cmp_eq_u32 s31, 1
	s_cbranch_scc1 Lrp_174
	s_cmp_eq_u32 s31, 2
	s_cbranch_scc1 Lrp_175
	s_cmp_eq_u32 s31, 3
	s_cbranch_scc1 Lrp_176
	s_cmp_eq_u32 s31, 4
	s_cbranch_scc1 Lrp_177
	s_cmp_eq_u32 s31, 5
	s_cbranch_scc1 Lrp_178
	s_cmp_eq_u32 s31, 6
	s_cbranch_scc1 Lrp_179
	s_cmp_eq_u32 s31, 7
	s_cbranch_scc1 Lrp_180
Lrp_173:
	v_max3_u32 v8, v128, v132, v136
	v_max_u32 v8, v8, v140
	v_cmp_eq_u32 vcc, -1, v8
	s_cbranch_vccz Lrt_172
	s_add_u32 s28, s28, 1
	s_cmp_gt_u32 s28, 20000
	s_cbranch_scc1 Lrr_171
	global_load_dwordx4 v[128:131], v24, s[40:41] offset:0 sc1
	global_load_dwordx4 v[132:135], v24, s[40:41] offset:256 sc1
	global_load_dwordx4 v[136:139], v24, s[40:41] offset:512 sc1
	global_load_dwordx4 v[140:143], v24, s[40:41] offset:768 sc1
	s_waitcnt vmcnt(0)
	s_branch Lrp_173
Lrp_174:
	v_max3_u32 v8, v144, v148, v152
	v_max_u32 v8, v8, v156
	v_cmp_eq_u32 vcc, -1, v8
	s_cbranch_vccz Lrt_172
	s_add_u32 s28, s28, 1
	s_cmp_gt_u32 s28, 20000
	s_cbranch_scc1 Lrr_171
	global_load_dwordx4 v[144:147], v24, s[42:43] offset:0 sc1
	global_load_dwordx4 v[148:151], v24, s[42:43] offset:256 sc1
	global_load_dwordx4 v[152:155], v24, s[42:43] offset:512 sc1
	global_load_dwordx4 v[156:159], v24, s[42:43] offset:768 sc1
	s_waitcnt vmcnt(0)
	s_branch Lrp_174
Lrp_175:
	v_max3_u32 v8, v160, v164, v168
	v_max_u32 v8, v8, v172
	v_cmp_eq_u32 vcc, -1, v8
	s_cbranch_vccz Lrt_172
	s_add_u32 s28, s28, 1
	s_cmp_gt_u32 s28, 20000
	s_cbranch_scc1 Lrr_171
	global_load_dwordx4 v[160:163], v24, s[44:45] offset:0 sc1
	global_load_dwordx4 v[164:167], v24, s[44:45] offset:256 sc1
	global_load_dwordx4 v[168:171], v24, s[44:45] offset:512 sc1
	global_load_dwordx4 v[172:175], v24, s[44:45] offset:768 sc1
	s_waitcnt vmcnt(0)
	s_branch Lrp_175
Lrp_176:
	v_max3_u32 v8, v176, v180, v184
	v_max_u32 v8, v8, v188
	v_cmp_eq_u32 vcc, -1, v8
	s_cbranch_vccz Lrt_172
	s_add_u32 s28, s28, 1
	s_cmp_gt_u32 s28, 20000
	s_cbranch_scc1 Lrr_171
	global_load_dwordx4 v[176:179], v24, s[46:47] offset:0 sc1
	global_load_dwordx4 v[180:183], v24, s[46:47] offset:256 sc1
	global_load_dwordx4 v[184:187], v24, s[46:47] offset:512 sc1
	global_load_dwordx4 v[188:191], v24, s[46:47] offset:768 sc1
	s_waitcnt vmcnt(0)
	s_branch Lrp_176
Lrp_177:
	v_max3_u32 v8, v192, v196, v200
	v_max_u32 v8, v8, v204
	v_cmp_eq_u32 vcc, -1, v8
	s_cbranch_vccz Lrt_172
	s_add_u32 s28, s28, 1
	s_cmp_gt_u32 s28, 20000
	s_cbranch_scc1 Lrr_171
	global_load_dwordx4 v[192:195], v24, s[48:49] offset:0 sc1
	global_load_dwordx4 v[196:199], v24, s[48:49] offset:256 sc1
	global_load_dwordx4 v[200:203], v24, s[48:49] offset:512 sc1
	global_load_dwordx4 v[204:207], v24, s[48:49] offset:768 sc1
	s_waitcnt vmcnt(0)
	s_branch Lrp_177
Lrp_178:
	v_max3_u32 v8, v208, v212, v216
	v_max_u32 v8, v8, v220
	v_cmp_eq_u32 vcc, -1, v8
	s_cbranch_vccz Lrt_172
	s_add_u32 s28, s28, 1
	s_cmp_gt_u32 s28, 20000
	s_cbranch_scc1 Lrr_171
	global_load_dwordx4 v[208:211], v24, s[50:51] offset:0 sc1
	global_load_dwordx4 v[212:215], v24, s[50:51] offset:256 sc1
	global_load_dwordx4 v[216:219], v24, s[50:51] offset:512 sc1
	global_load_dwordx4 v[220:223], v24, s[50:51] offset:768 sc1
	s_waitcnt vmcnt(0)
	s_branch Lrp_178
Lrp_179:
	v_max3_u32 v8, v224, v228, v232
	v_max_u32 v8, v8, v236
	v_cmp_eq_u32 vcc, -1, v8
	s_cbranch_vccz Lrt_172
	s_add_u32 s28, s28, 1
	s_cmp_gt_u32 s28, 20000
	s_cbranch_scc1 Lrr_171
	global_load_dwordx4 v[224:227], v24, s[52:53] offset:0 sc1
	global_load_dwordx4 v[228:231], v24, s[52:53] offset:256 sc1
	global_load_dwordx4 v[232:235], v24, s[52:53] offset:512 sc1
	global_load_dwordx4 v[236:239], v24, s[52:53] offset:768 sc1
	s_waitcnt vmcnt(0)
	s_branch Lrp_179
Lrp_180:
	v_max3_u32 v8, v240, v244, v248
	v_max_u32 v8, v8, v252
	v_cmp_eq_u32 vcc, -1, v8
	s_cbranch_vccz Lrt_172
	s_add_u32 s28, s28, 1
	s_cmp_gt_u32 s28, 20000
	s_cbranch_scc1 Lrr_171
	global_load_dwordx4 v[240:243], v24, s[54:55] offset:0 sc1
	global_load_dwordx4 v[244:247], v24, s[54:55] offset:256 sc1
	global_load_dwordx4 v[248:251], v24, s[54:55] offset:512 sc1
	global_load_dwordx4 v[252:255], v24, s[54:55] offset:768 sc1
	s_waitcnt vmcnt(0)
	s_branch Lrp_180
Lrt_172:
	v_max3_u32 v8, v128, v132, v136
	v_max_u32 v8, v8, v140
	v_cmp_eq_u32 vcc, -1, v8
	s_cbranch_vccz L_181
	global_load_dwordx4 v[128:131], v24, s[40:41] offset:0 sc1
	global_load_dwordx4 v[132:135], v24, s[40:41] offset:256 sc1
	global_load_dwordx4 v[136:139], v24, s[40:41] offset:512 sc1
	global_load_dwordx4 v[140:143], v24, s[40:41] offset:768 sc1
L_181:
	v_max3_u32 v8, v144, v148, v152
	v_max_u32 v8, v8, v156
	v_cmp_eq_u32 vcc, -1, v8
	s_cbranch_vccz L_182
	global_load_dwordx4 v[144:147], v24, s[42:43] offset:0 sc1
	global_load_dwordx4 v[148:151], v24, s[42:43] offset:256 sc1
	global_load_dwordx4 v[152:155], v24, s[42:43] offset:512 sc1
	global_load_dwordx4 v[156:159], v24, s[42:43] offset:768 sc1
L_182:
	v_max3_u32 v8, v160, v164, v168
	v_max_u32 v8, v8, v172
	v_cmp_eq_u32 vcc, -1, v8
	s_cbranch_vccz L_183
	global_load_dwordx4 v[160:163], v24, s[44:45] offset:0 sc1
	global_load_dwordx4 v[164:167], v24, s[44:45] offset:256 sc1
	global_load_dwordx4 v[168:171], v24, s[44:45] offset:512 sc1
	global_load_dwordx4 v[172:175], v24, s[44:45] offset:768 sc1
L_183:
	v_max3_u32 v8, v176, v180, v184
	v_max_u32 v8, v8, v188
	v_cmp_eq_u32 vcc, -1, v8
	s_cbranch_vccz L_184
	global_load_dwordx4 v[176:179], v24, s[46:47] offset:0 sc1
	global_load_dwordx4 v[180:183], v24, s[46:47] offset:256 sc1
	global_load_dwordx4 v[184:187], v24, s[46:47] offset:512 sc1
	global_load_dwordx4 v[188:191], v24, s[46:47] offset:768 sc1
L_184:
	v_max3_u32 v8, v192, v196, v200
	v_max_u32 v8, v8, v204
	v_cmp_eq_u32 vcc, -1, v8
	s_cbranch_vccz L_185
	global_load_dwordx4 v[192:195], v24, s[48:49] offset:0 sc1
	global_load_dwordx4 v[196:199], v24, s[48:49] offset:256 sc1
	global_load_dwordx4 v[200:203], v24, s[48:49] offset:512 sc1
	global_load_dwordx4 v[204:207], v24, s[48:49] offset:768 sc1
L_185:
	v_max3_u32 v8, v208, v212, v216
	v_max_u32 v8, v8, v220
	v_cmp_eq_u32 vcc, -1, v8
	s_cbranch_vccz L_186
	global_load_dwordx4 v[208:211], v24, s[50:51] offset:0 sc1
	global_load_dwordx4 v[212:215], v24, s[50:51] offset:256 sc1
	global_load_dwordx4 v[216:219], v24, s[50:51] offset:512 sc1
	global_load_dwordx4 v[220:223], v24, s[50:51] offset:768 sc1
L_186:
	v_max3_u32 v8, v224, v228, v232
	v_max_u32 v8, v8, v236
	v_cmp_eq_u32 vcc, -1, v8
	s_cbranch_vccz L_187
	global_load_dwordx4 v[224:227], v24, s[52:53] offset:0 sc1
	global_load_dwordx4 v[228:231], v24, s[52:53] offset:256 sc1
	global_load_dwordx4 v[232:235], v24, s[52:53] offset:512 sc1
	global_load_dwordx4 v[236:239], v24, s[52:53] offset:768 sc1
L_187:
	v_max3_u32 v8, v240, v244, v248
	v_max_u32 v8, v8, v252
	v_cmp_eq_u32 vcc, -1, v8
	s_cbranch_vccz L_188
	global_load_dwordx4 v[240:243], v24, s[54:55] offset:0 sc1
	global_load_dwordx4 v[244:247], v24, s[54:55] offset:256 sc1
	global_load_dwordx4 v[248:251], v24, s[54:55] offset:512 sc1
	global_load_dwordx4 v[252:255], v24, s[54:55] offset:768 sc1
L_188:
	s_waitcnt vmcnt(0)
Lrr_171:
	s_cmp_eq_u32 s29, 0
	s_cbranch_scc1 Lret2_126
	s_cmp_eq_u32 s29, 1
	s_cbranch_scc1 Lret2_127
	s_cmp_eq_u32 s29, 2
	s_cbranch_scc1 Lret2_128
	s_cmp_eq_u32 s29, 3
	s_cbranch_scc1 Lret2_129
	s_cmp_eq_u32 s29, 4
	s_cbranch_scc1 Lret2_130
	s_cmp_eq_u32 s29, 5
	s_cbranch_scc1 Lret2_131
	s_cmp_eq_u32 s29, 6
	s_cbranch_scc1 Lret2_132
	s_cmp_eq_u32 s29, 7
	s_cbranch_scc1 Lret2_133
	s_cmp_eq_u32 s29, 8
	s_cbranch_scc1 Lret2_134
	s_cmp_eq_u32 s29, 9
	s_cbranch_scc1 Lret2_135
	s_branch Lret2_136
Lfs_143:
Lfp_141:
	s_add_u32 s28, s28, 1
	s_cmp_gt_u32 s28, 20000
	s_cbranch_scc1 Lfv_144
	global_load_dwordx4 v[128:131], v24, s[40:41] offset:0 sc1
	global_load_dwordx4 v[132:135], v24, s[40:41] offset:256 sc1
	global_load_dwordx4 v[136:139], v24, s[40:41] offset:512 sc1
	global_load_dwordx4 v[140:143], v24, s[40:41] offset:768 sc1
	s_waitcnt vmcnt(0)
	v_max3_u32 v8, v128, v132, v136
	v_max_u32 v8, v8, v140
	v_cmp_eq_u32 vcc, -1, v8
	s_cbranch_vccnz Lfp_141
Lfv_144:
	s_add_u32 s42, s56, 32768
	s_addc_u32 s43, s57, 0
	global_load_dwordx4 v[144:147], v24, s[42:43] offset:0 sc1
	global_load_dwordx4 v[148:151], v24, s[42:43] offset:256 sc1
	global_load_dwordx4 v[152:155], v24, s[42:43] offset:512 sc1
	global_load_dwordx4 v[156:159], v24, s[42:43] offset:768 sc1
	s_add_u32 s44, s56, 65536
	s_addc_u32 s45, s57, 0
	global_load_dwordx4 v[160:163], v24, s[44:45] offset:0 sc1
	global_load_dwordx4 v[164:167], v24, s[44:45] offset:256 sc1
	global_load_dwordx4 v[168:171], v24, s[44:45] offset:512 sc1
	global_load_dwordx4 v[172:175], v24, s[44:45] offset:768 sc1
	s_add_u32 s46, s56, 98304
	s_addc_u32 s47, s57, 0
	global_load_dwordx4 v[176:179], v24, s[46:47] offset:0 sc1
	global_load_dwordx4 v[180:183], v24, s[46:47] offset:256 sc1
	global_load_dwordx4 v[184:187], v24, s[46:47] offset:512 sc1
	global_load_dwordx4 v[188:191], v24, s[46:47] offset:768 sc1
	s_branch Lfd_142
.p2align 8
L_tables:
.long 0x00003f80,0x00003f80,0x00003f80,0x00003f80,0x00003f80,0x3f353f35,0x3f80248d,0x3f35bf35
.long 0x00003f80,0x3f80248d,0x250dbf80,0xbf80a554,0x00003f80,0x3f35bf35,0xbf80a554,0x3f353f35
.long 0x00003f80,0x250dbf80,0x00003f80,0x250dbf80,0x00003f80,0xbf35bf35,0x3f80248d,0xbf353f35
.long 0x00003f80,0xbf80a554,0x250dbf80,0x3f80248d,0x00003f80,0xbf353f35,0xbf80a554,0xbf35bf35
.long 0x00003f80,0x00003f80,0x00003f80,0x00003f80,0x00003f80,0x3f353f35,0x3f80248d,0x3f35bf35
.long 0x00003f80,0x3f80248d,0x250dbf80,0xbf80a554,0x00003f80,0x3f35bf35,0xbf80a554,0x3f353f35
.long 0x00003f80,0x250dbf80,0x00003f80,0x250dbf80,0x00003f80,0xbf35bf35,0x3f80248d,0xbf353f35
.long 0x00003f80,0xbf80a554,0x250dbf80,0x3f80248d,0x00003f80,0xbf353f35,0xbf80a554,0xbf35bf35
.long 0x00003f80,0x00003f80,0x00003f80,0x00003f80,0x250dbf80,0xbf35bf35,0xbf80a554,0xbf353f35
.long 0x00003f80,0x3f80248d,0x250dbf80,0xbf80a554,0x250dbf80,0xbf353f35,0x3f80248d,0xbf35bf35
.long 0x00003f80,0x250dbf80,0x00003f80,0x250dbf80,0x250dbf80,0x3f353f35,0xbf80a554,0x3f35bf35
.long 0x00003f80,0xbf80a554,0x250dbf80,0x3f80248d,0x250dbf80,0x3f35bf35,0x3f80248d,0x3f353f35
.long 0x00003f80,0x00003f80,0x00003f80,0x00003f80,0x250dbf80,0xbf35bf35,0xbf80a554,0xbf353f35
.long 0x00003f80,0x3f80248d,0x250dbf80,0xbf80a554,0x250dbf80,0xbf353f35,0x3f80248d,0xbf35bf35
.long 0x00003f80,0x250dbf80,0x00003f80,0x250dbf80,0x250dbf80,0x3f353f35,0xbf80a554,0x3f35bf35
.long 0x00003f80,0xbf80a554,0x250dbf80,0x3f80248d,0x250dbf80,0x3f35bf35,0x3f80248d,0x3f353f35
.long 0x00003f80,0x00003f80,0x00003f80,0x00003f80,0x00003f80,0x3f353f35,0x3f80248d,0x3f35bf35
.long 0x00003f80,0x3f80248d,0x250dbf80,0xbf80a554,0x00003f80,0x3f35bf35,0xbf80a554,0x3f353f35
.long 0x00003f80,0x250dbf80,0x00003f80,0x250dbf80,0x00003f80,0xbf35bf35,0x3f80248d,0xbf353f35
.long 0x00003f80,0xbf80a554,0x250dbf80,0x3f80248d,0x00003f80,0xbf353f35,0xbf80a554,0xbf35bf35
.long 0x00003f80,0x00003f80,0x00003f80,0x00003f80,0x00003f80,0x3f353f35,0x3f80248d,0x3f35bf35
.long 0x00003f80,0x3f80248d,0x250dbf80,0xbf80a554,0x00003f80,0x3f35bf35,0xbf80a554,0x3f353f35
.long 0x00003f80,0x250dbf80,0x00003f80,0x250dbf80,0x00003f80,0xbf35bf35,0x3f80248d,0xbf353f35
.long 0x00003f80,0xbf80a554,0x250dbf80,0x3f80248d,0x00003f80,0xbf353f35,0xbf80a554,0xbf35bf35
.long 0x00003f80,0x00003f80,0x00003f80,0x00003f80,0x250dbf80,0xbf35bf35,0xbf80a554,0xbf353f35
.long 0x00003f80,0x3f80248d,0x250dbf80,0xbf80a554,0x250dbf80,0xbf353f35,0x3f80248d,0xbf35bf35
.long 0x00003f80,0x250dbf80,0x00003f80,0x250dbf80,0x250dbf80,0x3f353f35,0xbf80a554,0x3f35bf35
.long 0x00003f80,0xbf80a554,0x250dbf80,0x3f80248d,0x250dbf80,0x3f35bf35,0x3f80248d,0x3f353f35
.long 0x00003f80,0x00003f80,0x00003f80,0x00003f80,0x250dbf80,0xbf35bf35,0xbf80a554,0xbf353f35
.long 0x00003f80,0x3f80248d,0x250dbf80,0xbf80a554,0x250dbf80,0xbf353f35,0x3f80248d,0xbf35bf35
.long 0x00003f80,0x250dbf80,0x00003f80,0x250dbf80,0x250dbf80,0x3f353f35,0xbf80a554,0x3f35bf35
.long 0x00003f80,0xbf80a554,0x250dbf80,0x3f80248d,0x250dbf80,0x3f35bf35,0x3f80248d,0x3f353f35
.long 0x3f808000,0x3f808000,0x3f808000,0x3f808000,0x3f808000,0x3f35bf35,0x248dbf80,0xbf35bf35
.long 0x3f808000,0x248dbf80,0xbf80a50d,0xa5543f80,0x3f808000,0xbf35bf35,0xa5543f80,0x3f35bf35
.long 0x3f808000,0xbf80a50d,0x3f808000,0xbf80a50d,0x3f808000,0xbf353f35,0x248dbf80,0x3f353f35
.long 0x3f808000,0xa5543f80,0xbf80a50d,0x248dbf80,0x3f808000,0x3f353f35,0xa5543f80,0xbf353f35
.long 0x3f808000,0x3f808000,0x3f808000,0x3f808000,0x3f808000,0x3f35bf35,0x248dbf80,0xbf35bf35
.long 0x3f808000,0x248dbf80,0xbf80a50d,0xa5543f80,0x3f808000,0xbf35bf35,0xa5543f80,0x3f35bf35
.long 0x3f808000,0xbf80a50d,0x3f808000,0xbf80a50d,0x3f808000,0xbf353f35,0x248dbf80,0x3f353f35
.long 0x3f808000,0xa5543f80,0xbf80a50d,0x248dbf80,0x3f808000,0x3f353f35,0xa5543f80,0xbf353f35
.long 0x3f808000,0x3f808000,0x3f808000,0x3f808000,0xbf80a50d,0xbf353f35,0xa5543f80,0x3f353f35
.long 0x3f808000,0x248dbf80,0xbf80a50d,0xa5543f80,0xbf80a50d,0x3f353f35,0x248dbf80,0xbf353f35
.long 0x3f808000,0xbf80a50d,0x3f808000,0xbf80a50d,0xbf80a50d,0x3f35bf35,0xa5543f80,0xbf35bf35
.long 0x3f808000,0xa5543f80,0xbf80a50d,0x248dbf80,0xbf80a50d,0xbf35bf35,0x248dbf80,0x3f35bf35
.long 0x3f808000,0x3f808000,0x3f808000,0x3f808000,0xbf80a50d,0xbf353f35,0xa5543f80,0x3f353f35
.long 0x3f808000,0x248dbf80,0xbf80a50d,0xa5543f80,0xbf80a50d,0x3f353f35,0x248dbf80,0xbf353f35
.long 0x3f808000,0xbf80a50d,0x3f808000,0xbf80a50d,0xbf80a50d,0x3f35bf35,0xa5543f80,0xbf35bf35
.long 0x3f808000,0xa5543f80,0xbf80a50d,0x248dbf80,0xbf80a50d,0xbf35bf35,0x248dbf80,0x3f35bf35
.long 0x3f808000,0x3f808000,0x3f808000,0x3f808000,0x3f808000,0x3f35bf35,0x248dbf80,0xbf35bf35
.long 0x3f808000,0x248dbf80,0xbf80a50d,0xa5543f80,0x3f808000,0xbf35bf35,0xa5543f80,0x3f35bf35
.long 0x3f808000,0xbf80a50d,0x3f808000,0xbf80a50d,0x3f808000,0xbf353f35,0x248dbf80,0x3f353f35
.long 0x3f808000,0xa5543f80,0xbf80a50d,0x248dbf80,0x3f808000,0x3f353f35,0xa5543f80,0xbf353f35
.long 0x3f808000,0x3f808000,0x3f808000,0x3f808000,0x3f808000,0x3f35bf35,0x248dbf80,0xbf35bf35
.long 0x3f808000,0x248dbf80,0xbf80a50d,0xa5543f80,0x3f808000,0xbf35bf35,0xa5543f80,0x3f35bf35
.long 0x3f808000,0xbf80a50d,0x3f808000,0xbf80a50d,0x3f808000,0xbf353f35,0x248dbf80,0x3f353f35
.long 0x3f808000,0xa5543f80,0xbf80a50d,0x248dbf80,0x3f808000,0x3f353f35,0xa5543f80,0xbf353f35
.long 0x3f808000,0x3f808000,0x3f808000,0x3f808000,0xbf80a50d,0xbf353f35,0xa5543f80,0x3f353f35
.long 0x3f808000,0x248dbf80,0xbf80a50d,0xa5543f80,0xbf80a50d,0x3f353f35,0x248dbf80,0xbf353f35
.long 0x3f808000,0xbf80a50d,0x3f808000,0xbf80a50d,0xbf80a50d,0x3f35bf35,0xa5543f80,0xbf35bf35
.long 0x3f808000,0xa5543f80,0xbf80a50d,0x248dbf80,0xbf80a50d,0xbf35bf35,0x248dbf80,0x3f35bf35
.long 0x3f808000,0x3f808000,0x3f808000,0x3f808000,0xbf80a50d,0xbf353f35,0xa5543f80,0x3f353f35
.long 0x3f808000,0x248dbf80,0xbf80a50d,0xa5543f80,0xbf80a50d,0x3f353f35,0x248dbf80,0xbf353f35
.long 0x3f808000,0xbf80a50d,0x3f808000,0xbf80a50d,0xbf80a50d,0x3f35bf35,0xa5543f80,0xbf35bf35
.long 0x3f808000,0xa5543f80,0xbf80a50d,0x248dbf80,0xbf80a50d,0xbf35bf35,0x248dbf80,0x3f35bf35
.long 0x00003f80,0x00003f80,0x00003f80,0x00003f80,0x3ec43f6d,0x3f6d3ec4,0x3f6dbec4,0x3ec4bf6d
.long 0x3f353f35,0x3f35bf35,0xbf35bf35,0xbf353f35,0x3f6d3ec4,0xbec4bf6d,0xbec43f6d,0x3f6dbec4
.long 0x3f80248d,0xbf80a554,0x3f80248d,0xbf80a554,0x3f6dbec4,0xbec43f6d,0xbec4bf6d,0x3f6d3ec4
.long 0x3f35bf35,0x3f353f35,0xbf353f35,0xbf35bf35,0x3ec4bf6d,0x3f6dbec4,0x3f6d3ec4,0x3ec43f6d
.long 0x250dbf80,0x250dbf80,0x250dbf80,0x250dbf80,0xbec4bf6d,0xbf6dbec4,0xbf6d3ec4,0xbec43f6d
.long 0xbf35bf35,0xbf353f35,0x3f353f35,0x3f35bf35,0xbf6dbec4,0x3ec43f6d,0x3ec4bf6d,0xbf6d3ec4
.long 0xbf80a554,0x3f80248d,0xbf80a554,0x3f80248d,0xbf6d3ec4,0x3ec4bf6d,0x3ec43f6d,0xbf6dbec4
.long 0xbf353f35,0xbf35bf35,0x3f35bf35,0x3f353f35,0xbec43f6d,0xbf6d3ec4,0xbf6dbec4,0xbec4bf6d
.long 0x00003f80,0x00003f80,0x00003f80,0x00003f80,0xbec4bf6d,0xbf6dbec4,0xbf6d3ec4,0xbec43f6d
.long 0x3f353f35,0x3f35bf35,0xbf35bf35,0xbf353f35,0xbf6dbec4,0x3ec43f6d,0x3ec4bf6d,0xbf6d3ec4
.long 0x3f80248d,0xbf80a554,0x3f80248d,0xbf80a554,0xbf6d3ec4,0x3ec4bf6d,0x3ec43f6d,0xbf6dbec4
.long 0x3f35bf35,0x3f353f35,0xbf353f35,0xbf35bf35,0xbec43f6d,0xbf6d3ec4,0xbf6dbec4,0xbec4bf6d
.long 0x250dbf80,0x250dbf80,0x250dbf80,0x250dbf80,0x3ec43f6d,0x3f6d3ec4,0x3f6dbec4,0x3ec4bf6d
.long 0xbf35bf35,0xbf353f35,0x3f353f35,0x3f35bf35,0x3f6d3ec4,0xbec4bf6d,0xbec43f6d,0x3f6dbec4
.long 0xbf80a554,0x3f80248d,0xbf80a554,0x3f80248d,0x3f6dbec4,0xbec43f6d,0xbec4bf6d,0x3f6d3ec4
.long 0xbf353f35,0xbf35bf35,0x3f35bf35,0x3f353f35,0x3ec4bf6d,0x3f6dbec4,0x3f6d3ec4,0x3ec43f6d
.long 0x00003f80,0x00003f80,0x00003f80,0x00003f80,0x3ec43f6d,0x3f6d3ec4,0x3f6dbec4,0x3ec4bf6d
.long 0x3f353f35,0x3f35bf35,0xbf35bf35,0xbf353f35,0x3f6d3ec4,0xbec4bf6d,0xbec43f6d,0x3f6dbec4
.long 0x3f80248d,0xbf80a554,0x3f80248d,0xbf80a554,0x3f6dbec4,0xbec43f6d,0xbec4bf6d,0x3f6d3ec4
.long 0x3f35bf35,0x3f353f35,0xbf353f35,0xbf35bf35,0x3ec4bf6d,0x3f6dbec4,0x3f6d3ec4,0x3ec43f6d
.long 0x250dbf80,0x250dbf80,0x250dbf80,0x250dbf80,0xbec4bf6d,0xbf6dbec4,0xbf6d3ec4,0xbec43f6d
.long 0xbf35bf35,0xbf353f35,0x3f353f35,0x3f35bf35,0xbf6dbec4,0x3ec43f6d,0x3ec4bf6d,0xbf6d3ec4
.long 0xbf80a554,0x3f80248d,0xbf80a554,0x3f80248d,0xbf6d3ec4,0x3ec4bf6d,0x3ec43f6d,0xbf6dbec4
.long 0xbf353f35,0xbf35bf35,0x3f35bf35,0x3f353f35,0xbec43f6d,0xbf6d3ec4,0xbf6dbec4,0xbec4bf6d
.long 0x00003f80,0x00003f80,0x00003f80,0x00003f80,0xbec4bf6d,0xbf6dbec4,0xbf6d3ec4,0xbec43f6d
.long 0x3f353f35,0x3f35bf35,0xbf35bf35,0xbf353f35,0xbf6dbec4,0x3ec43f6d,0x3ec4bf6d,0xbf6d3ec4
.long 0x3f80248d,0xbf80a554,0x3f80248d,0xbf80a554,0xbf6d3ec4,0x3ec4bf6d,0x3ec43f6d,0xbf6dbec4
.long 0x3f35bf35,0x3f353f35,0xbf353f35,0xbf35bf35,0xbec43f6d,0xbf6d3ec4,0xbf6dbec4,0xbec4bf6d
.long 0x250dbf80,0x250dbf80,0x250dbf80,0x250dbf80,0x3ec43f6d,0x3f6d3ec4,0x3f6dbec4,0x3ec4bf6d
.long 0xbf35bf35,0xbf353f35,0x3f353f35,0x3f35bf35,0x3f6d3ec4,0xbec4bf6d,0xbec43f6d,0x3f6dbec4
.long 0xbf80a554,0x3f80248d,0xbf80a554,0x3f80248d,0x3f6dbec4,0xbec43f6d,0xbec4bf6d,0x3f6d3ec4
.long 0xbf353f35,0xbf35bf35,0x3f35bf35,0x3f353f35,0x3ec4bf6d,0x3f6dbec4,0x3f6d3ec4,0x3ec43f6d
.long 0x3f808000,0x3f808000,0x3f808000,0x3f808000,0x3f6dbec4,0x3ec4bf6d,0xbec4bf6d,0xbf6dbec4
.long 0x3f35bf35,0xbf35bf35,0xbf353f35,0x3f353f35,0x3ec4bf6d,0xbf6d3ec4,0x3f6d3ec4,0xbec4bf6d
.long 0x248dbf80,0xa5543f80,0x248dbf80,0xa5543f80,0xbec4bf6d,0x3f6d3ec4,0xbf6d3ec4,0x3ec4bf6d
.long 0xbf35bf35,0x3f35bf35,0x3f353f35,0xbf353f35,0xbf6dbec4,0xbec4bf6d,0x3ec4bf6d,0x3f6dbec4
.long 0xbf80a50d,0xbf80a50d,0xbf80a50d,0xbf80a50d,0xbf6d3ec4,0xbec43f6d,0x3ec43f6d,0x3f6d3ec4
.long 0xbf353f35,0x3f353f35,0x3f35bf35,0xbf35bf35,0xbec43f6d,0x3f6dbec4,0xbf6dbec4,0x3ec43f6d
.long 0xa5543f80,0x248dbf80,0xa5543f80,0x248dbf80,0x3ec43f6d,0xbf6dbec4,0x3f6dbec4,0xbec43f6d
.long 0x3f353f35,0xbf353f35,0xbf35bf35,0x3f35bf35,0x3f6d3ec4,0x3ec43f6d,0xbec43f6d,0xbf6d3ec4
.long 0x3f808000,0x3f808000,0x3f808000,0x3f808000,0xbf6d3ec4,0xbec43f6d,0x3ec43f6d,0x3f6d3ec4
.long 0x3f35bf35,0xbf35bf35,0xbf353f35,0x3f353f35,0xbec43f6d,0x3f6dbec4,0xbf6dbec4,0x3ec43f6d
.long 0x248dbf80,0xa5543f80,0x248dbf80,0xa5543f80,0x3ec43f6d,0xbf6dbec4,0x3f6dbec4,0xbec43f6d
.long 0xbf35bf35,0x3f35bf35,0x3f353f35,0xbf353f35,0x3f6d3ec4,0x3ec43f6d,0xbec43f6d,0xbf6d3ec4
.long 0xbf80a50d,0xbf80a50d,0xbf80a50d,0xbf80a50d,0x3f6dbec4,0x3ec4bf6d,0xbec4bf6d,0xbf6dbec4
.long 0xbf353f35,0x3f353f35,0x3f35bf35,0xbf35bf35,0x3ec4bf6d,0xbf6d3ec4,0x3f6d3ec4,0xbec4bf6d
.long 0xa5543f80,0x248dbf80,0xa5543f80,0x248dbf80,0xbec4bf6d,0x3f6d3ec4,0xbf6d3ec4,0x3ec4bf6d
.long 0x3f353f35,0xbf353f35,0xbf35bf35,0x3f35bf35,0xbf6dbec4,0xbec4bf6d,0x3ec4bf6d,0x3f6dbec4
.long 0x3f808000,0x3f808000,0x3f808000,0x3f808000,0x3f6dbec4,0x3ec4bf6d,0xbec4bf6d,0xbf6dbec4
.long 0x3f35bf35,0xbf35bf35,0xbf353f35,0x3f353f35,0x3ec4bf6d,0xbf6d3ec4,0x3f6d3ec4,0xbec4bf6d
.long 0x248dbf80,0xa5543f80,0x248dbf80,0xa5543f80,0xbec4bf6d,0x3f6d3ec4,0xbf6d3ec4,0x3ec4bf6d
.long 0xbf35bf35,0x3f35bf35,0x3f353f35,0xbf353f35,0xbf6dbec4,0xbec4bf6d,0x3ec4bf6d,0x3f6dbec4
.long 0xbf80a50d,0xbf80a50d,0xbf80a50d,0xbf80a50d,0xbf6d3ec4,0xbec43f6d,0x3ec43f6d,0x3f6d3ec4
.long 0xbf353f35,0x3f353f35,0x3f35bf35,0xbf35bf35,0xbec43f6d,0x3f6dbec4,0xbf6dbec4,0x3ec43f6d
.long 0xa5543f80,0x248dbf80,0xa5543f80,0x248dbf80,0x3ec43f6d,0xbf6dbec4,0x3f6dbec4,0xbec43f6d
.long 0x3f353f35,0xbf353f35,0xbf35bf35,0x3f35bf35,0x3f6d3ec4,0x3ec43f6d,0xbec43f6d,0xbf6d3ec4
.long 0x3f808000,0x3f808000,0x3f808000,0x3f808000,0xbf6d3ec4,0xbec43f6d,0x3ec43f6d,0x3f6d3ec4
.long 0x3f35bf35,0xbf35bf35,0xbf353f35,0x3f353f35,0xbec43f6d,0x3f6dbec4,0xbf6dbec4,0x3ec43f6d
.long 0x248dbf80,0xa5543f80,0x248dbf80,0xa5543f80,0x3ec43f6d,0xbf6dbec4,0x3f6dbec4,0xbec43f6d
.long 0xbf35bf35,0x3f35bf35,0x3f353f35,0xbf353f35,0x3f6d3ec4,0x3ec43f6d,0xbec43f6d,0xbf6d3ec4
.long 0xbf80a50d,0xbf80a50d,0xbf80a50d,0xbf80a50d,0x3f6dbec4,0x3ec4bf6d,0xbec4bf6d,0xbf6dbec4
.long 0xbf353f35,0x3f353f35,0x3f35bf35,0xbf35bf35,0x3ec4bf6d,0xbf6d3ec4,0x3f6d3ec4,0xbec4bf6d
.long 0xa5543f80,0x248dbf80,0xa5543f80,0x248dbf80,0xbec4bf6d,0x3f6d3ec4,0xbf6d3ec4,0x3ec4bf6d
.long 0x3f353f35,0xbf353f35,0xbf35bf35,0x3f35bf35,0xbf6dbec4,0xbec4bf6d,0x3ec4bf6d,0x3f6dbec4
.long 0x00003f80,0x3ec43f6d,0x3f353f35,0x3f6d3ec4,0x00003f80,0x3f6d3ec4,0x3f35bf35,0xbec4bf6d
.long 0x00003f80,0x3f6dbec4,0xbf35bf35,0xbec43f6d,0x00003f80,0x3ec4bf6d,0xbf353f35,0x3f6dbec4
.long 0x00003f80,0xbec4bf6d,0x3f353f35,0xbf6dbec4,0x00003f80,0xbf6dbec4,0x3f35bf35,0x3ec43f6d
.long 0x00003f80,0xbf6d3ec4,0xbf35bf35,0x3ec4bf6d,0x00003f80,0xbec43f6d,0xbf353f35,0xbf6d3ec4
.long 0x00003f80,0x3ec43f6d,0x3f353f35,0x3f6d3ec4,0x00003f80,0x3f6d3ec4,0x3f35bf35,0xbec4bf6d
.long 0x00003f80,0x3f6dbec4,0xbf35bf35,0xbec43f6d,0x00003f80,0x3ec4bf6d,0xbf353f35,0x3f6dbec4
.long 0x00003f80,0xbec4bf6d,0x3f353f35,0xbf6dbec4,0x00003f80,0xbf6dbec4,0x3f35bf35,0x3ec43f6d
.long 0x00003f80,0xbf6d3ec4,0xbf35bf35,0x3ec4bf6d,0x00003f80,0xbec43f6d,0xbf353f35,0xbf6d3ec4
.long 0x3f80248d,0x3f6dbec4,0x3f35bf35,0x3ec4bf6d,0xbf80a554,0xbec43f6d,0x3f353f35,0x3f6dbec4
.long 0x3f80248d,0xbec4bf6d,0xbf353f35,0x3f6d3ec4,0xbf80a554,0x3f6d3ec4,0xbf35bf35,0x3ec43f6d
.long 0x3f80248d,0xbf6d3ec4,0x3f35bf35,0xbec43f6d,0xbf80a554,0x3ec4bf6d,0x3f353f35,0xbf6d3ec4
.long 0x3f80248d,0x3ec43f6d,0xbf353f35,0xbf6dbec4,0xbf80a554,0xbf6dbec4,0xbf35bf35,0xbec4bf6d
.long 0x3f80248d,0x3f6dbec4,0x3f35bf35,0x3ec4bf6d,0xbf80a554,0xbec43f6d,0x3f353f35,0x3f6dbec4
.long 0x3f80248d,0xbec4bf6d,0xbf353f35,0x3f6d3ec4,0xbf80a554,0x3f6d3ec4,0xbf35bf35,0x3ec43f6d
.long 0x3f80248d,0xbf6d3ec4,0x3f35bf35,0xbec43f6d,0xbf80a554,0x3ec4bf6d,0x3f353f35,0xbf6d3ec4
.long 0x3f80248d,0x3ec43f6d,0xbf353f35,0xbf6dbec4,0xbf80a554,0xbf6dbec4,0xbf35bf35,0xbec4bf6d
.long 0x250dbf80,0xbec4bf6d,0xbf35bf35,0xbf6dbec4,0x250dbf80,0xbf6dbec4,0xbf353f35,0x3ec43f6d
.long 0x250dbf80,0xbf6d3ec4,0x3f353f35,0x3ec4bf6d,0x250dbf80,0xbec43f6d,0x3f35bf35,0xbf6d3ec4
.long 0x250dbf80,0x3ec43f6d,0xbf35bf35,0x3f6d3ec4,0x250dbf80,0x3f6d3ec4,0xbf353f35,0xbec4bf6d
.long 0x250dbf80,0x3f6dbec4,0x3f353f35,0xbec43f6d,0x250dbf80,0x3ec4bf6d,0x3f35bf35,0x3f6dbec4
.long 0x250dbf80,0xbec4bf6d,0xbf35bf35,0xbf6dbec4,0x250dbf80,0xbf6dbec4,0xbf353f35,0x3ec43f6d
.long 0x250dbf80,0xbf6d3ec4,0x3f353f35,0x3ec4bf6d,0x250dbf80,0xbec43f6d,0x3f35bf35,0xbf6d3ec4
.long 0x250dbf80,0x3ec43f6d,0xbf35bf35,0x3f6d3ec4,0x250dbf80,0x3f6d3ec4,0xbf353f35,0xbec4bf6d
.long 0x250dbf80,0x3f6dbec4,0x3f353f35,0xbec43f6d,0x250dbf80,0x3ec4bf6d,0x3f35bf35,0x3f6dbec4
.long 0xbf80a554,0xbf6d3ec4,0xbf353f35,0xbec43f6d,0x3f80248d,0x3ec4bf6d,0xbf35bf35,0xbf6d3ec4
.long 0xbf80a554,0x3ec43f6d,0x3f35bf35,0xbf6dbec4,0x3f80248d,0xbf6dbec4,0x3f353f35,0xbec4bf6d
.long 0xbf80a554,0x3f6dbec4,0xbf353f35,0x3ec4bf6d,0x3f80248d,0xbec43f6d,0xbf35bf35,0x3f6dbec4
.long 0xbf80a554,0xbec4bf6d,0x3f35bf35,0x3f6d3ec4,0x3f80248d,0x3f6d3ec4,0x3f353f35,0x3ec43f6d
.long 0xbf80a554,0xbf6d3ec4,0xbf353f35,0xbec43f6d,0x3f80248d,0x3ec4bf6d,0xbf35bf35,0xbf6d3ec4
.long 0xbf80a554,0x3ec43f6d,0x3f35bf35,0xbf6dbec4,0x3f80248d,0xbf6dbec4,0x3f353f35,0xbec4bf6d
.long 0xbf80a554,0x3f6dbec4,0xbf353f35,0x3ec4bf6d,0x3f80248d,0xbec43f6d,0xbf35bf35,0x3f6dbec4
.long 0xbf80a554,0xbec4bf6d,0x3f35bf35,0x3f6d3ec4,0x3f80248d,0x3f6d3ec4,0x3f353f35,0x3ec43f6d
.long 0x3f808000,0x3f6dbec4,0x3f35bf35,0x3ec4bf6d,0x3f808000,0x3ec4bf6d,0xbf35bf35,0xbf6d3ec4
.long 0x3f808000,0xbec4bf6d,0xbf353f35,0x3f6d3ec4,0x3f808000,0xbf6dbec4,0x3f353f35,0xbec4bf6d
.long 0x3f808000,0xbf6d3ec4,0x3f35bf35,0xbec43f6d,0x3f808000,0xbec43f6d,0xbf35bf35,0x3f6dbec4
.long 0x3f808000,0x3ec43f6d,0xbf353f35,0xbf6dbec4,0x3f808000,0x3f6d3ec4,0x3f353f35,0x3ec43f6d
.long 0x3f808000,0x3f6dbec4,0x3f35bf35,0x3ec4bf6d,0x3f808000,0x3ec4bf6d,0xbf35bf35,0xbf6d3ec4
.long 0x3f808000,0xbec4bf6d,0xbf353f35,0x3f6d3ec4,0x3f808000,0xbf6dbec4,0x3f353f35,0xbec4bf6d
.long 0x3f808000,0xbf6d3ec4,0x3f35bf35,0xbec43f6d,0x3f808000,0xbec43f6d,0xbf35bf35,0x3f6dbec4
.long 0x3f808000,0x3ec43f6d,0xbf353f35,0xbf6dbec4,0x3f808000,0x3f6d3ec4,0x3f353f35,0x3ec43f6d
.long 0x248dbf80,0xbec4bf6d,0xbf35bf35,0xbf6dbec4,0xa5543f80,0x3f6d3ec4,0x3f35bf35,0xbec4bf6d
.long 0x248dbf80,0xbf6d3ec4,0x3f353f35,0x3ec4bf6d,0xa5543f80,0x3ec4bf6d,0xbf353f35,0x3f6dbec4
.long 0x248dbf80,0x3ec43f6d,0xbf35bf35,0x3f6d3ec4,0xa5543f80,0xbf6dbec4,0x3f35bf35,0x3ec43f6d
.long 0x248dbf80,0x3f6dbec4,0x3f353f35,0xbec43f6d,0xa5543f80,0xbec43f6d,0xbf353f35,0xbf6d3ec4
.long 0x248dbf80,0xbec4bf6d,0xbf35bf35,0xbf6dbec4,0xa5543f80,0x3f6d3ec4,0x3f35bf35,0xbec4bf6d
.long 0x248dbf80,0xbf6d3ec4,0x3f353f35,0x3ec4bf6d,0xa5543f80,0x3ec4bf6d,0xbf353f35,0x3f6dbec4
.long 0x248dbf80,0x3ec43f6d,0xbf35bf35,0x3f6d3ec4,0xa5543f80,0xbf6dbec4,0x3f35bf35,0x3ec43f6d
.long 0x248dbf80,0x3f6dbec4,0x3f353f35,0xbec43f6d,0xa5543f80,0xbec43f6d,0xbf353f35,0xbf6d3ec4
.long 0xbf80a50d,0xbf6d3ec4,0xbf353f35,0xbec43f6d,0xbf80a50d,0xbec43f6d,0x3f353f35,0x3f6dbec4
.long 0xbf80a50d,0x3ec43f6d,0x3f35bf35,0xbf6dbec4,0xbf80a50d,0x3f6d3ec4,0xbf35bf35,0x3ec43f6d
.long 0xbf80a50d,0x3f6dbec4,0xbf353f35,0x3ec4bf6d,0xbf80a50d,0x3ec4bf6d,0x3f353f35,0xbf6d3ec4
.long 0xbf80a50d,0xbec4bf6d,0x3f35bf35,0x3f6d3ec4,0xbf80a50d,0xbf6dbec4,0xbf35bf35,0xbec4bf6d
.long 0xbf80a50d,0xbf6d3ec4,0xbf353f35,0xbec43f6d,0xbf80a50d,0xbec43f6d,0x3f353f35,0x3f6dbec4
.long 0xbf80a50d,0x3ec43f6d,0x3f35bf35,0xbf6dbec4,0xbf80a50d,0x3f6d3ec4,0xbf35bf35,0x3ec43f6d
.long 0xbf80a50d,0x3f6dbec4,0xbf353f35,0x3ec4bf6d,0xbf80a50d,0x3ec4bf6d,0x3f353f35,0xbf6d3ec4
.long 0xbf80a50d,0xbec4bf6d,0x3f35bf35,0x3f6d3ec4,0xbf80a50d,0xbf6dbec4,0xbf35bf35,0xbec4bf6d
.long 0xa5543f80,0x3ec43f6d,0x3f353f35,0x3f6d3ec4,0x248dbf80,0xbf6dbec4,0xbf353f35,0x3ec43f6d
.long 0xa5543f80,0x3f6dbec4,0xbf35bf35,0xbec43f6d,0x248dbf80,0xbec43f6d,0x3f35bf35,0xbf6d3ec4
.long 0xa5543f80,0xbec4bf6d,0x3f353f35,0xbf6dbec4,0x248dbf80,0x3f6d3ec4,0xbf353f35,0xbec4bf6d
.long 0xa5543f80,0xbf6d3ec4,0xbf35bf35,0x3ec4bf6d,0x248dbf80,0x3ec4bf6d,0x3f35bf35,0x3f6dbec4
.long 0xa5543f80,0x3ec43f6d,0x3f353f35,0x3f6d3ec4,0x248dbf80,0xbf6dbec4,0xbf353f35,0x3ec43f6d
.long 0xa5543f80,0x3f6dbec4,0xbf35bf35,0xbec43f6d,0x248dbf80,0xbec43f6d,0x3f35bf35,0xbf6d3ec4
.long 0xa5543f80,0xbec4bf6d,0x3f353f35,0xbf6dbec4,0x248dbf80,0x3f6d3ec4,0xbf353f35,0xbec4bf6d
.long 0xa5543f80,0xbf6d3ec4,0xbf35bf35,0x3ec4bf6d,0x248dbf80,0x3ec4bf6d,0x3f35bf35,0x3f6dbec4
.long 0x3e483f7b,0x3f0e3f55,0x3f553f0e,0x3f7b3e48,0x3f0e3f55,0x3f7bbe48,0x3e48bf7b,0xbf55bf0e
.long 0x3f553f0e,0x3e48bf7b,0xbf7b3e48,0x3f0e3f55,0x3f7b3e48,0xbf55bf0e,0x3f0e3f55,0xbe48bf7b
.long 0x3f7bbe48,0xbf553f0e,0x3f0ebf55,0xbe483f7b,0x3f55bf0e,0x3e483f7b,0xbf7bbe48,0x3f0ebf55
.long 0x3f0ebf55,0x3f7b3e48,0x3e483f7b,0xbf553f0e,0x3e48bf7b,0x3f0ebf55,0x3f55bf0e,0x3f7bbe48
.long 0xbe48bf7b,0xbf0ebf55,0xbf55bf0e,0xbf7bbe48,0xbf0ebf55,0xbf7b3e48,0xbe483f7b,0x3f553f0e
.long 0xbf55bf0e,0xbe483f7b,0x3f7bbe48,0xbf0ebf55,0xbf7bbe48,0x3f553f0e,0xbf0ebf55,0x3e483f7b
.long 0xbf7b3e48,0x3f55bf0e,0xbf0e3f55,0x3e48bf7b,0xbf553f0e,0xbe48bf7b,0x3f7b3e48,0xbf0e3f55
.long 0xbf0e3f55,0xbf7bbe48,0xbe48bf7b,0x3f55bf0e,0xbe483f7b,0xbf0e3f55,0xbf553f0e,0xbf7b3e48
.long 0x3f7bbe48,0x3f55bf0e,0x3f0ebf55,0x3e48bf7b,0xbf553f0e,0x3e483f7b,0x3f7b3e48,0x3f0ebf55
.long 0x3f0ebf55,0xbf7bbe48,0x3e483f7b,0x3f55bf0e,0xbe483f7b,0x3f0ebf55,0xbf553f0e,0x3f7bbe48
.long 0xbe48bf7b,0x3f0e3f55,0xbf55bf0e,0x3f7b3e48,0x3f0e3f55,0xbf7b3e48,0x3e48bf7b,0x3f553f0e
.long 0xbf55bf0e,0x3e48bf7b,0x3f7bbe48,0x3f0e3f55,0x3f7b3e48,0x3f553f0e,0x3f0e3f55,0x3e483f7b
.long 0xbf7b3e48,0xbf553f0e,0xbf0e3f55,0xbe483f7b,0x3f55bf0e,0xbe48bf7b,0xbf7bbe48,0xbf0e3f55
.long 0xbf0e3f55,0x3f7b3e48,0xbe48bf7b,0xbf553f0e,0x3e48bf7b,0xbf0e3f55,0x3f55bf0e,0xbf7b3e48
.long 0x3e483f7b,0xbf0ebf55,0x3f553f0e,0xbf7bbe48,0xbf0ebf55,0x3f7bbe48,0xbe483f7b,0xbf55bf0e
.long 0x3f553f0e,0xbe483f7b,0xbf7b3e48,0xbf0ebf55,0xbf7bbe48,0xbf55bf0e,0xbf0ebf55,0xbe48bf7b
.long 0xbe48bf7b,0xbf0ebf55,0xbf55bf0e,0xbf7bbe48,0xbf0ebf55,0xbf7b3e48,0xbe483f7b,0x3f553f0e
.long 0xbf55bf0e,0xbe483f7b,0x3f7bbe48,0xbf0ebf55,0xbf7bbe48,0x3f553f0e,0xbf0ebf55,0x3e483f7b
.long 0xbf7b3e48,0x3f55bf0e,0xbf0e3f55,0x3e48bf7b,0xbf553f0e,0xbe48bf7b,0x3f7b3e48,0xbf0e3f55
.long 0xbf0e3f55,0xbf7bbe48,0xbe48bf7b,0x3f55bf0e,0xbe483f7b,0xbf0e3f55,0xbf553f0e,0xbf7b3e48
.long 0x3e483f7b,0x3f0e3f55,0x3f553f0e,0x3f7b3e48,0x3f0e3f55,0x3f7bbe48,0x3e48bf7b,0xbf55bf0e
.long 0x3f553f0e,0x3e48bf7b,0xbf7b3e48,0x3f0e3f55,0x3f7b3e48,0xbf55bf0e,0x3f0e3f55,0xbe48bf7b
.long 0x3f7bbe48,0xbf553f0e,0x3f0ebf55,0xbe483f7b,0x3f55bf0e,0x3e483f7b,0xbf7bbe48,0x3f0ebf55
.long 0x3f0ebf55,0x3f7b3e48,0x3e483f7b,0xbf553f0e,0x3e48bf7b,0x3f0ebf55,0x3f55bf0e,0x3f7bbe48
.long 0xbf7b3e48,0xbf553f0e,0xbf0e3f55,0xbe483f7b,0x3f55bf0e,0xbe48bf7b,0xbf7bbe48,0xbf0e3f55
.long 0xbf0e3f55,0x3f7b3e48,0xbe48bf7b,0xbf553f0e,0x3e48bf7b,0xbf0e3f55,0x3f55bf0e,0xbf7b3e48
.long 0x3e483f7b,0xbf0ebf55,0x3f553f0e,0xbf7bbe48,0xbf0ebf55,0x3f7bbe48,0xbe483f7b,0xbf55bf0e
.long 0x3f553f0e,0xbe483f7b,0xbf7b3e48,0xbf0ebf55,0xbf7bbe48,0xbf55bf0e,0xbf0ebf55,0xbe48bf7b
.long 0x3f7bbe48,0x3f55bf0e,0x3f0ebf55,0x3e48bf7b,0xbf553f0e,0x3e483f7b,0x3f7b3e48,0x3f0ebf55
.long 0x3f0ebf55,0xbf7bbe48,0x3e483f7b,0x3f55bf0e,0xbe483f7b,0x3f0ebf55,0xbf553f0e,0x3f7bbe48
.long 0xbe48bf7b,0x3f0e3f55,0xbf55bf0e,0x3f7b3e48,0x3f0e3f55,0xbf7b3e48,0x3e48bf7b,0x3f553f0e
.long 0xbf55bf0e,0x3e48bf7b,0x3f7bbe48,0x3f0e3f55,0x3f7b3e48,0x3f553f0e,0x3f0e3f55,0x3e483f7b
.long 0x3f7bbe48,0x3f55bf0e,0x3f0ebf55,0x3e48bf7b,0x3f55bf0e,0xbe48bf7b,0xbf7bbe48,0xbf0e3f55
.long 0x3f0ebf55,0xbf7bbe48,0x3e483f7b,0x3f55bf0e,0x3e48bf7b,0xbf0e3f55,0x3f55bf0e,0xbf7b3e48
.long 0xbe48bf7b,0x3f0e3f55,0xbf55bf0e,0x3f7b3e48,0xbf0ebf55,0x3f7bbe48,0xbe483f7b,0xbf55bf0e
.long 0xbf55bf0e,0x3e48bf7b,0x3f7bbe48,0x3f0e3f55,0xbf7bbe48,0xbf55bf0e,0xbf0ebf55,0xbe48bf7b
.long 0xbf7b3e48,0xbf553f0e,0xbf0e3f55,0xbe483f7b,0xbf553f0e,0x3e483f7b,0x3f7b3e48,0x3f0ebf55
.long 0xbf0e3f55,0x3f7b3e48,0xbe48bf7b,0xbf553f0e,0xbe483f7b,0x3f0ebf55,0xbf553f0e,0x3f7bbe48
.long 0x3e483f7b,0xbf0ebf55,0x3f553f0e,0xbf7bbe48,0x3f0e3f55,0xbf7b3e48,0x3e48bf7b,0x3f553f0e
.long 0x3f553f0e,0xbe483f7b,0xbf7b3e48,0xbf0ebf55,0x3f7b3e48,0x3f553f0e,0x3f0e3f55,0x3e483f7b
.long 0xbe48bf7b,0xbf0ebf55,0xbf55bf0e,0xbf7bbe48,0x3f0e3f55,0x3f7bbe48,0x3e48bf7b,0xbf55bf0e
.long 0xbf55bf0e,0xbe483f7b,0x3f7bbe48,0xbf0ebf55,0x3f7b3e48,0xbf55bf0e,0x3f0e3f55,0xbe48bf7b
.long 0xbf7b3e48,0x3f55bf0e,0xbf0e3f55,0x3e48bf7b,0x3f55bf0e,0x3e483f7b,0xbf7bbe48,0x3f0ebf55
.long 0xbf0e3f55,0xbf7bbe48,0xbe48bf7b,0x3f55bf0e,0x3e48bf7b,0x3f0ebf55,0x3f55bf0e,0x3f7bbe48
.long 0x3e483f7b,0x3f0e3f55,0x3f553f0e,0x3f7b3e48,0xbf0ebf55,0xbf7b3e48,0xbe483f7b,0x3f553f0e
.long 0x3f553f0e,0x3e48bf7b,0xbf7b3e48,0x3f0e3f55,0xbf7bbe48,0x3f553f0e,0xbf0ebf55,0x3e483f7b
.long 0x3f7bbe48,0xbf553f0e,0x3f0ebf55,0xbe483f7b,0xbf553f0e,0xbe48bf7b,0x3f7b3e48,0xbf0e3f55
.long 0x3f0ebf55,0x3f7b3e48,0x3e483f7b,0xbf553f0e,0xbe483f7b,0xbf0e3f55,0xbf553f0e,0xbf7b3e48
.long 0xbf7b3e48,0xbf553f0e,0xbf0e3f55,0xbe483f7b,0xbf553f0e,0x3e483f7b,0x3f7b3e48,0x3f0ebf55
.long 0xbf0e3f55,0x3f7b3e48,0xbe48bf7b,0xbf553f0e,0xbe483f7b,0x3f0ebf55,0xbf553f0e,0x3f7bbe48
.long 0x3e483f7b,0xbf0ebf55,0x3f553f0e,0xbf7bbe48,0x3f0e3f55,0xbf7b3e48,0x3e48bf7b,0x3f553f0e
.long 0x3f553f0e,0xbe483f7b,0xbf7b3e48,0xbf0ebf55,0x3f7b3e48,0x3f553f0e,0x3f0e3f55,0x3e483f7b
.long 0x3f7bbe48,0x3f55bf0e,0x3f0ebf55,0x3e48bf7b,0x3f55bf0e,0xbe48bf7b,0xbf7bbe48,0xbf0e3f55
.long 0x3f0ebf55,0xbf7bbe48,0x3e483f7b,0x3f55bf0e,0x3e48bf7b,0xbf0e3f55,0x3f55bf0e,0xbf7b3e48
.long 0xbe48bf7b,0x3f0e3f55,0xbf55bf0e,0x3f7b3e48,0xbf0ebf55,0x3f7bbe48,0xbe483f7b,0xbf55bf0e
.long 0xbf55bf0e,0x3e48bf7b,0x3f7bbe48,0x3f0e3f55,0xbf7bbe48,0xbf55bf0e,0xbf0ebf55,0xbe48bf7b
.long 0x3e483f7b,0x3f0e3f55,0x3f553f0e,0x3f7b3e48,0xbf0ebf55,0xbf7b3e48,0xbe483f7b,0x3f553f0e
.long 0x3f553f0e,0x3e48bf7b,0xbf7b3e48,0x3f0e3f55,0xbf7bbe48,0x3f553f0e,0xbf0ebf55,0x3e483f7b
.long 0x3f7bbe48,0xbf553f0e,0x3f0ebf55,0xbe483f7b,0xbf553f0e,0xbe48bf7b,0x3f7b3e48,0xbf0e3f55
.long 0x3f0ebf55,0x3f7b3e48,0x3e483f7b,0xbf553f0e,0xbe483f7b,0xbf0e3f55,0xbf553f0e,0xbf7b3e48
.long 0xbe48bf7b,0xbf0ebf55,0xbf55bf0e,0xbf7bbe48,0x3f0e3f55,0x3f7bbe48,0x3e48bf7b,0xbf55bf0e
.long 0xbf55bf0e,0xbe483f7b,0x3f7bbe48,0xbf0ebf55,0x3f7b3e48,0xbf55bf0e,0x3f0e3f55,0xbe48bf7b
.long 0xbf7b3e48,0x3f55bf0e,0xbf0e3f55,0x3e48bf7b,0x3f55bf0e,0x3e483f7b,0xbf7bbe48,0x3f0ebf55
.long 0xbf0e3f55,0xbf7bbe48,0xbe48bf7b,0x3f55bf0e,0x3e48bf7b,0x3f0ebf55,0x3f55bf0e,0x3f7bbe48
.long 0x00003f80,0x00003f80,0x00003f80,0x00003f80,0x00003f80,0x3ec43f6d,0x3f353f35,0x3f6d3ec4
.long 0x00003f80,0x3f353f35,0x3f80248d,0x3f35bf35,0x00003f80,0x3f6d3ec4,0x3f35bf35,0xbec4bf6d
.long 0x00003f80,0x3f80248d,0x250dbf80,0xbf80a554,0x00003f80,0x3f6dbec4,0xbf35bf35,0xbec43f6d
.long 0x00003f80,0x3f35bf35,0xbf80a554,0x3f353f35,0x00003f80,0x3ec4bf6d,0xbf353f35,0x3f6dbec4
.long 0x00003f80,0x250dbf80,0x00003f80,0x250dbf80,0x00003f80,0xbec4bf6d,0x3f353f35,0xbf6dbec4
.long 0x00003f80,0xbf35bf35,0x3f80248d,0xbf353f35,0x00003f80,0xbf6dbec4,0x3f35bf35,0x3ec43f6d
.long 0x00003f80,0xbf80a554,0x250dbf80,0x3f80248d,0x00003f80,0xbf6d3ec4,0xbf35bf35,0x3ec4bf6d
.long 0x00003f80,0xbf353f35,0xbf80a554,0xbf35bf35,0x00003f80,0xbec43f6d,0xbf353f35,0xbf6d3ec4
.long 0x00003f80,0x00003f80,0x00003f80,0x00003f80,0x3f80248d,0x3f6dbec4,0x3f35bf35,0x3ec4bf6d
.long 0x250dbf80,0xbf35bf35,0xbf80a554,0xbf353f35,0xbf80a554,0xbec43f6d,0x3f353f35,0x3f6dbec4
.long 0x00003f80,0x3f80248d,0x250dbf80,0xbf80a554,0x3f80248d,0xbec4bf6d,0xbf353f35,0x3f6d3ec4
.long 0x250dbf80,0xbf353f35,0x3f80248d,0xbf35bf35,0xbf80a554,0x3f6d3ec4,0xbf35bf35,0x3ec43f6d
.long 0x00003f80,0x250dbf80,0x00003f80,0x250dbf80,0x3f80248d,0xbf6d3ec4,0x3f35bf35,0xbec43f6d
.long 0x250dbf80,0x3f353f35,0xbf80a554,0x3f35bf35,0xbf80a554,0x3ec4bf6d,0x3f353f35,0xbf6d3ec4
.long 0x00003f80,0xbf80a554,0x250dbf80,0x3f80248d,0x3f80248d,0x3ec43f6d,0xbf353f35,0xbf6dbec4
.long 0x250dbf80,0x3f35bf35,0x3f80248d,0x3f353f35,0xbf80a554,0xbf6dbec4,0xbf35bf35,0xbec4bf6d
.long 0x00003f80,0x00003f80,0x00003f80,0x00003f80,0x250dbf80,0xbec4bf6d,0xbf35bf35,0xbf6dbec4
.long 0x00003f80,0x3f353f35,0x3f80248d,0x3f35bf35,0x250dbf80,0xbf6dbec4,0xbf353f35,0x3ec43f6d
.long 0x00003f80,0x3f80248d,0x250dbf80,0xbf80a554,0x250dbf80,0xbf6d3ec4,0x3f353f35,0x3ec4bf6d
.long 0x00003f80,0x3f35bf35,0xbf80a554,0x3f353f35,0x250dbf80,0xbec43f6d,0x3f35bf35,0xbf6d3ec4
.long 0x00003f80,0x250dbf80,0x00003f80,0x250dbf80,0x250dbf80,0x3ec43f6d,0xbf35bf35,0x3f6d3ec4
.long 0x00003f80,0xbf35bf35,0x3f80248d,0xbf353f35,0x250dbf80,0x3f6d3ec4,0xbf353f35,0xbec4bf6d
.long 0x00003f80,0xbf80a554,0x250dbf80,0x3f80248d,0x250dbf80,0x3f6dbec4,0x3f353f35,0xbec43f6d
.long 0x00003f80,0xbf353f35,0xbf80a554,0xbf35bf35,0x250dbf80,0x3ec4bf6d,0x3f35bf35,0x3f6dbec4
.long 0x00003f80,0x00003f80,0x00003f80,0x00003f80,0xbf80a554,0xbf6d3ec4,0xbf353f35,0xbec43f6d
.long 0x250dbf80,0xbf35bf35,0xbf80a554,0xbf353f35,0x3f80248d,0x3ec4bf6d,0xbf35bf35,0xbf6d3ec4
.long 0x00003f80,0x3f80248d,0x250dbf80,0xbf80a554,0xbf80a554,0x3ec43f6d,0x3f35bf35,0xbf6dbec4
.long 0x250dbf80,0xbf353f35,0x3f80248d,0xbf35bf35,0x3f80248d,0xbf6dbec4,0x3f353f35,0xbec4bf6d
.long 0x00003f80,0x250dbf80,0x00003f80,0x250dbf80,0xbf80a554,0x3f6dbec4,0xbf353f35,0x3ec4bf6d
.long 0x250dbf80,0x3f353f35,0xbf80a554,0x3f35bf35,0x3f80248d,0xbec43f6d,0xbf35bf35,0x3f6dbec4
.long 0x00003f80,0xbf80a554,0x250dbf80,0x3f80248d,0xbf80a554,0xbec4bf6d,0x3f35bf35,0x3f6d3ec4
.long 0x250dbf80,0x3f35bf35,0x3f80248d,0x3f353f35,0x3f80248d,0x3f6d3ec4,0x3f353f35,0x3ec43f6d
.long 0x3f808000,0x3f808000,0x3f808000,0x3f808000,0x3f808000,0x3f6dbec4,0x3f35bf35,0x3ec4bf6d
.long 0x3f808000,0x3f35bf35,0x248dbf80,0xbf35bf35,0x3f808000,0x3ec4bf6d,0xbf35bf35,0xbf6d3ec4
.long 0x3f808000,0x248dbf80,0xbf80a50d,0xa5543f80,0x3f808000,0xbec4bf6d,0xbf353f35,0x3f6d3ec4
.long 0x3f808000,0xbf35bf35,0xa5543f80,0x3f35bf35,0x3f808000,0xbf6dbec4,0x3f353f35,0xbec4bf6d
.long 0x3f808000,0xbf80a50d,0x3f808000,0xbf80a50d,0x3f808000,0xbf6d3ec4,0x3f35bf35,0xbec43f6d
.long 0x3f808000,0xbf353f35,0x248dbf80,0x3f353f35,0x3f808000,0xbec43f6d,0xbf35bf35,0x3f6dbec4
.long 0x3f808000,0xa5543f80,0xbf80a50d,0x248dbf80,0x3f808000,0x3ec43f6d,0xbf353f35,0xbf6dbec4
.long 0x3f808000,0x3f353f35,0xa5543f80,0xbf353f35,0x3f808000,0x3f6d3ec4,0x3f353f35,0x3ec43f6d
.long 0x3f808000,0x3f808000,0x3f808000,0x3f808000,0x248dbf80,0xbec4bf6d,0xbf35bf35,0xbf6dbec4
.long 0xbf80a50d,0xbf353f35,0xa5543f80,0x3f353f35,0xa5543f80,0x3f6d3ec4,0x3f35bf35,0xbec4bf6d
.long 0x3f808000,0x248dbf80,0xbf80a50d,0xa5543f80,0x248dbf80,0xbf6d3ec4,0x3f353f35,0x3ec4bf6d
.long 0xbf80a50d,0x3f353f35,0x248dbf80,0xbf353f35,0xa5543f80,0x3ec4bf6d,0xbf353f35,0x3f6dbec4
.long 0x3f808000,0xbf80a50d,0x3f808000,0xbf80a50d,0x248dbf80,0x3ec43f6d,0xbf35bf35,0x3f6d3ec4
.long 0xbf80a50d,0x3f35bf35,0xa5543f80,0xbf35bf35,0xa5543f80,0xbf6dbec4,0x3f35bf35,0x3ec43f6d
.long 0x3f808000,0xa5543f80,0xbf80a50d,0x248dbf80,0x248dbf80,0x3f6dbec4,0x3f353f35,0xbec43f6d
.long 0xbf80a50d,0xbf35bf35,0x248dbf80,0x3f35bf35,0xa5543f80,0xbec43f6d,0xbf353f35,0xbf6d3ec4
.long 0x3f808000,0x3f808000,0x3f808000,0x3f808000,0xbf80a50d,0xbf6d3ec4,0xbf353f35,0xbec43f6d
.long 0x3f808000,0x3f35bf35,0x248dbf80,0xbf35bf35,0xbf80a50d,0xbec43f6d,0x3f353f35,0x3f6dbec4
.long 0x3f808000,0x248dbf80,0xbf80a50d,0xa5543f80,0xbf80a50d,0x3ec43f6d,0x3f35bf35,0xbf6dbec4
.long 0x3f808000,0xbf35bf35,0xa5543f80,0x3f35bf35,0xbf80a50d,0x3f6d3ec4,0xbf35bf35,0x3ec43f6d
.long 0x3f808000,0xbf80a50d,0x3f808000,0xbf80a50d,0xbf80a50d,0x3f6dbec4,0xbf353f35,0x3ec4bf6d
.long 0x3f808000,0xbf353f35,0x248dbf80,0x3f353f35,0xbf80a50d,0x3ec4bf6d,0x3f353f35,0xbf6d3ec4
.long 0x3f808000,0xa5543f80,0xbf80a50d,0x248dbf80,0xbf80a50d,0xbec4bf6d,0x3f35bf35,0x3f6d3ec4
.long 0x3f808000,0x3f353f35,0xa5543f80,0xbf353f35,0xbf80a50d,0xbf6dbec4,0xbf35bf35,0xbec4bf6d
.long 0x3f808000,0x3f808000,0x3f808000,0x3f808000,0xa5543f80,0x3ec43f6d,0x3f353f35,0x3f6d3ec4
.long 0xbf80a50d,0xbf353f35,0xa5543f80,0x3f353f35,0x248dbf80,0xbf6dbec4,0xbf353f35,0x3ec43f6d
.long 0x3f808000,0x248dbf80,0xbf80a50d,0xa5543f80,0xa5543f80,0x3f6dbec4,0xbf35bf35,0xbec43f6d
.long 0xbf80a50d,0x3f353f35,0x248dbf80,0xbf353f35,0x248dbf80,0xbec43f6d,0x3f35bf35,0xbf6d3ec4
.long 0x3f808000,0xbf80a50d,0x3f808000,0xbf80a50d,0xa5543f80,0xbec4bf6d,0x3f353f35,0xbf6dbec4
.long 0xbf80a50d,0x3f35bf35,0xa5543f80,0xbf35bf35,0x248dbf80,0x3f6d3ec4,0xbf353f35,0xbec4bf6d
.long 0x3f808000,0xa5543f80,0xbf80a50d,0x248dbf80,0xa5543f80,0xbf6d3ec4,0xbf35bf35,0x3ec4bf6d
.long 0xbf80a50d,0xbf35bf35,0x248dbf80,0x3f35bf35,0x248dbf80,0x3ec4bf6d,0x3f35bf35,0x3f6dbec4
.section .rodata,"a"
.p2align 6
.amdhsa_kernel sequential_preLN__spectral_gfnet__mixer_token_mlp__prompt_kernel
  .amdhsa_next_free_vgpr 512
  .amdhsa_next_free_sgpr 102
  .amdhsa_accum_offset 256
  .amdhsa_group_segment_fixed_size 0
  .amdhsa_kernarg_size 88
  .amdhsa_user_sgpr_count 2
  .amdhsa_user_sgpr_kernarg_segment_ptr 1
  .amdhsa_system_sgpr_workgroup_id_x 1
.end_amdhsa_kernel
```
